```python
import torch

def _softmax(x, axis=-1):
    return torch.softmax(x, dim=axis)
def _gelu(x):
    return torch.nn.functional.gelu(x, approximate="tanh")
def _silu(x):
    return torch.nn.functional.silu(x)
def _sigmoid(x):
    return torch.sigmoid(x)
def _layernorm(x, axis=-1, eps=1e-5):
    m = x.mean(dim=axis, keepdim=True)
    v = x.var(dim=axis, keepdim=True, unbiased=False)
    return (x - m) / torch.sqrt(v + eps)
def _scatter_add(tgt, idx, src, axis=0):
    return tgt.clone().index_add_(axis, idx, src)
def _segment_sum(src, seg, n):
    out = torch.zeros((n,) + src.shape[1:], dtype=src.dtype)
    return out.index_add_(0, seg, src)
def _pad(x, pw):
    flat = tuple(v for pair in reversed(pw) for v in pair)
    return torch.nn.functional.pad(x, flat)

kernel_name = 'standalone__deep_cross_xdeepfm__recsys'

def setup_inputs():

    _w = (lambda a: (lambda t: t.to(torch.bfloat16) if t.is_floating_point() else t)(torch.as_tensor(a)))
    B, F, D, L = 4096, 26, 16, 6
    V = min(1000, 100000)
    Din = F * D
    return {
        "idx": _w((lambda lo, hi, *s: torch.randint(lo, hi, s))(0, V, B, F).to(torch.int64)),
        "table": _w((lambda *s: torch.randn(*s, dtype=torch.bfloat16) * 0.8)(V, D)),
        "ws_cin": _w((lambda *s: torch.randn(*s, dtype=torch.bfloat16) * 0.4)(L, F, F, F) * (1.0 / F)),
        "w_cin_out": _w((lambda *s: torch.randn(*s, dtype=torch.bfloat16) * 0.4)(L * F) * ((L * F) ** -0.5)),
        "w_dnn1": _w((lambda *s: torch.randn(*s, dtype=torch.bfloat16) * 0.8)(Din, Din) * (Din ** -0.5)),
        "b_dnn1": _w((lambda *s: torch.randn(*s, dtype=torch.bfloat16) * 3.2)(Din) * 0.1),
        "w_dnn2": _w((lambda *s: torch.randn(*s, dtype=torch.bfloat16) * 0.4)(Din) * (Din ** -0.5)),
        "b_out": _w((lambda *s: torch.randn(*s, dtype=torch.bfloat16) * 0.4)(1)),
    }

def reference(idx, table, ws_cin, w_cin_out, w_dnn1, b_dnn1, w_dnn2, b_out):
    x0 = table[idx]
    B = x0.shape[0]
    L = ws_cin.shape[0]
    xk = x0
    pooled = []
    for l in range(L):
        xk = torch.einsum('bid,bjd,hij->bhd', xk, x0, ws_cin[l])
        pooled.append(xk.sum(axis=-1))
    p_plus = torch.stack(pooled, axis=1).reshape(B, -1)
    logit_cin = p_plus @ w_cin_out
    h = x0.reshape(B, -1)
    h = _gelu(h @ w_dnn1 + b_dnn1)
    logit_dnn = h @ w_dnn2
    return logit_cin + logit_dnn + b_out
```

```asm
; @launch grid=(256,1,1) block=(768,1,1) lds=163840
.amdgcn_target "amdgcn-amd-amdhsa--gfx950"
.text
.globl standalone__deep_cross_xdeepfm__recsys_kernel
.p2align 8
.type standalone__deep_cross_xdeepfm__recsys_kernel,@function
standalone__deep_cross_xdeepfm__recsys_kernel:
    s_cmp_ge_u32 s2, 256
    s_cbranch_scc1 L_end
    s_load_dwordx16 s[16:31], s[0:1], 0
    s_getpc_b64 s[38:39]
L_pc:
    s_and_b32 s41, s2, 0xf8
    v_and_b32 v3, 7, v0
    v_add_lshl_u32 v6, v3, s41, 7
    v_min_u32 v3, L_code_end-L_pc-4, v6
    global_load_dword v164, v3, s[38:39]
    v_min_u32 v6, 31996, v6
    s_bfe_u32 s57, s2, 0x20003
    s_lshr_b32 s41, s2, 5
    s_lshl_b32 s41, s41, 3
    s_and_b32 s56, s2, 7
    s_or_b32 s56, s56, s41
    s_lshl_b32 s59, s56, 2
    s_add_u32 s59, s59, s57
    s_mul_i32 s41, s59, 416
    v_lshrrev_b32 v7, 1, v0
    v_add_lshl_u32 v7, v7, s41, 2
    v_bfe_u32 v8, v0, 1, 5
    v_add_lshl_u32 v8, v8, s41, 2
    v_lshlrev_b32 v160, 4, v0
    v_add_u32 v4, 12288, v160
    v_add_u32 v5, 24576, v160
    s_waitcnt lgkmcnt(0)
    global_load_dword v161, v7, s[16:17]
    global_load_dword v162, v8, s[16:17] offset:1536
    global_load_dword v164, v6, s[18:19]
    global_load_dwordx4 v[148:151], v160, s[20:21]
    global_load_dwordx4 v[152:155], v4, s[20:21]
    global_load_dwordx4 v[156:159], v5, s[20:21]
    s_load_dwordx4 s[32:35], s[0:1], 64
    s_load_dwordx2 s[36:37], s[0:1], 80
    v_lshrrev_b32 v3, 6, v0
    v_and_b32 v1, 63, v0
    v_readfirstlane_b32 s3, v3
    v_mov_b32 v165, 163520
    v_mov_b32 v166, 1
    v_mov_b32 v167, 0
    v_and_b32 v3, 15, v0
    v_lshl_add_u32 v3, v3, 2, v165
    ds_write_b32 v3, v167
    v_add_u32 v160, 82656, v160
    s_and_b32 s47, s3, 3
    v_and_b32 v0, 255, v0
    v_lshlrev_b32 v2, 2, v0
    v_add_u32 v2, L_items2-L_pc, v2
    s_waitcnt lgkmcnt(0)
    s_mov_b32 s12, s20
    s_and_b32 s13, s21, 0xffff
    s_mov_b32 s14, 210912
    s_mov_b32 s15, 0x00020000
    s_mov_b32 s4, s16
    s_and_b32 s5, s17, 0xffff
    s_mov_b32 s6, 425984
    s_mov_b32 s7, 0x00020000
    s_mov_b32 s8, s18
    s_and_b32 s9, s19, 0xffff
    s_mov_b32 s10, 32000
    s_mov_b32 s11, 0x00020000
    s_mov_b32 s48, s24
    s_and_b32 s49, s25, 0xffff
    s_mov_b32 s50, 346112
    s_mov_b32 s51, 0x00020000
    s_mov_b32 s52, s22
    s_and_b32 s53, s23, 0xffff
    s_mov_b32 s54, 312
    s_mov_b32 s55, 0x00020000
    s_barrier
    v_and_b32 v3, 1, v1
    v_lshlrev_b32 v3, 4, v3
    s_lshl_b32 s40, s3, 10
    s_add_u32 m0, s40, 40960
    s_waitcnt vmcnt(4)
    v_lshl_add_u32 v161, v161, 5, v3
    v_lshl_add_u32 v162, v162, 5, v3
    buffer_load_dwordx4 v161, s[8:11], 0 offen lds
    s_cmp_ge_u32 s3, 8
    s_cbranch_scc1 L_H2
    s_cmp_ge_u32 s3, 4
    s_cbranch_scc1 L_H1
    s_setprio 2
    global_load_dword v52, v2, s[38:39]
    v_bfe_u32 v4, v1, 4, 1
    s_lshl_b32 s41, s3, 2
    v_add_u32 v4, s41, v4
    v_mul_u32_u24 v4, 832, v4
    v_and_b32 v5, 15, v1
    v_lshl_add_u32 v4, v5, 3, v4
    v_add_u32 v15, 40960, v4
    v_and_b32 v8, 31, v1
    v_lshrrev_b32 v9, 5, v1
    v_mov_b32 v10, 26
    v_cmp_gt_u32 vcc, 25, v8
    v_mov_b32 v5, 0
    v_mov_b32 v6, 0
    v_cndmask_b32 v11, v10, v8, vcc
    v_mov_b32 v10, 25
    v_cmp_eq_u32 vcc, 28, v8
    v_mov_b32 v7, 0x7f800000
    s_nop 0
    v_cndmask_b32 v11, v11, v10, vcc
    v_mul_u32_u24 v12, 1424, v11
    v_add_u32 v12, 121104, v12
    v_mul_u32_u24 v13, 208, v9
    v_add_u32 v3, v12, v13
    v_mul_u32_u24 v13, 80, v9
    v_add_u32 v4, v12, v13
    v_add_u32 v4, 1248, v4
    v_min_u32 v11, 25, v11
    v_mul_u32_u24 v12, 816, v11
    v_mul_u32_u24 v13, 400, v9
    v_add_u32 v2, v12, v13
    v_add_u32 v2, 61440, v2
    v_mov_b32 v14, 0x05040100
    v_mov_b32 v10, 0x07060302
    v_cmp_eq_u32 vcc, 0, v9
    v_bfe_u32 v11, v1, 4, 1
    v_lshl_add_u32 v11, v11, 1, v9
    v_cndmask_b32 v14, v10, v14, vcc
    s_lshl_b32 s40, s3, 5
    s_add_u32 s40, s40, 163136
    v_lshl_add_u32 v13, v11, 2, s40
    v_mov_b32 v12, v3
    s_waitcnt vmcnt(4)
    v_lshlrev_b32 v58, 16, v148
    v_and_b32 v59, 0xffff0000, v148
    v_cvt_pk_f16_f32 v148, v58, v59
    v_lshlrev_b32 v60, 16, v149
    v_and_b32 v61, 0xffff0000, v149
    v_cvt_pk_f16_f32 v149, v60, v61
    v_lshlrev_b32 v58, 16, v150
    v_and_b32 v59, 0xffff0000, v150
    v_cvt_pk_f16_f32 v150, v58, v59
    v_lshlrev_b32 v60, 16, v151
    v_and_b32 v61, 0xffff0000, v151
    v_cvt_pk_f16_f32 v151, v60, v61
    ds_write_b128 v160, v[148:151] offset:0
    s_waitcnt vmcnt(3)
    v_lshlrev_b32 v58, 16, v152
    v_and_b32 v59, 0xffff0000, v152
    v_cvt_pk_f16_f32 v152, v58, v59
    v_lshlrev_b32 v60, 16, v153
    v_and_b32 v61, 0xffff0000, v153
    v_cvt_pk_f16_f32 v153, v60, v61
    v_lshlrev_b32 v58, 16, v154
    v_and_b32 v59, 0xffff0000, v154
    v_cvt_pk_f16_f32 v154, v58, v59
    v_lshlrev_b32 v60, 16, v155
    v_and_b32 v61, 0xffff0000, v155
    v_cvt_pk_f16_f32 v155, v60, v61
    v_max3_f32 v58, abs(v58), abs(v59), abs(v60)
    v_cmp_le_f32 vcc, 0x3a800000, v58
    s_cbranch_vccnz L_wok1
    s_mov_b64 exec, 1
    ds_add_u32 v165, v166 offset:56
    s_mov_b64 exec, -1
L_wok1:
    ds_write_b128 v160, v[152:155] offset:12288
    s_waitcnt vmcnt(2)
    v_lshlrev_b32 v58, 16, v156
    v_and_b32 v59, 0xffff0000, v156
    v_cvt_pk_f16_f32 v156, v58, v59
    v_lshlrev_b32 v60, 16, v157
    v_and_b32 v61, 0xffff0000, v157
    v_cvt_pk_f16_f32 v157, v60, v61
    v_lshlrev_b32 v58, 16, v158
    v_and_b32 v59, 0xffff0000, v158
    v_cvt_pk_f16_f32 v158, v58, v59
    v_lshlrev_b32 v60, 16, v159
    v_and_b32 v61, 0xffff0000, v159
    v_cvt_pk_f16_f32 v159, v60, v61
    ds_write_b128 v160, v[156:159] offset:24576
    s_waitcnt lgkmcnt(0)
    s_mov_b64 exec, 1
    ds_add_u32 v165, v166 offset:0
    s_mov_b64 exec, -1
    s_waitcnt vmcnt(0)
    v_and_b32 v58, 0xff, v52
    v_bfe_u32 v59, v52, 8, 8
    v_bfe_u32 v60, v52, 16, 8
    v_lshrrev_b32 v61, 28, v52
    v_mul_u32_u24 v53, 104, v58
    v_lshl_add_u32 v53, v59, 2, v53
    v_mul_u32_u24 v54, 104, v59
    v_lshl_add_u32 v54, v58, 2, v54
    v_mul_u32_u24 v58, 1352, v61
    v_add_u32 v58, 82656, v58
    v_add_u32 v53, v53, v58
    v_add_u32 v54, v54, v58
    v_mul_u32_u24 v58, 816, v61
    v_lshl_add_u32 v55, v60, 2, v58
    v_add_u32 v55, 61440, v55
    v_bfe_u32 v59, v52, 24, 1
    v_mov_b32 v58, 0x0c0c0c0c
    v_cmp_eq_u32 vcc, 0, v59
    v_mov_b32 v56, 0x05040100
    v_mov_b32 v57, 0x07060302
    v_cndmask_b32 v56, v58, v56, vcc
    v_cndmask_b32 v57, v58, v57, vcc
    s_branch L_wf3
L_wf2:
    s_sleep 1
L_wf3:
    ds_read_b32 v167, v165 offset:0
    s_waitcnt lgkmcnt(0)
    v_readfirstlane_b32 s40, v167
    s_cmp_lt_u32 s40, 12
    s_cbranch_scc1 L_wf2
    ds_read_b32 v58, v53 offset:0
    ds_read_b32 v59, v53 offset:52
    ds_read_b32 v60, v54 offset:0
    ds_read_b32 v61, v54 offset:52
    ds_read_b32 v62, v53 offset:5408
    ds_read_b32 v63, v53 offset:5460
    ds_read_b32 v64, v54 offset:5408
    ds_read_b32 v65, v54 offset:5460
    s_mov_b64 exec, 1
    ds_add_u32 v165, v166 offset:8
    s_mov_b64 exec, -1
    s_waitcnt lgkmcnt(5)
    v_perm_b32 v70, v61, v60, v56
    v_perm_b32 v71, v61, v60, v57
    v_pk_add_f16 v70, v58, v70
    v_pk_add_f16 v71, v59, v71
    ds_read_b32 v66, v53 offset:10816
    ds_read_b32 v67, v53 offset:10868
    ds_read_b32 v68, v54 offset:10816
    ds_read_b32 v69, v54 offset:10868
    ds_write_b32 v55, v70 offset:0
    ds_write_b32 v55, v71 offset:400
    s_waitcnt lgkmcnt(7)
    v_perm_b32 v72, v65, v64, v56
    v_perm_b32 v73, v65, v64, v57
    v_pk_add_f16 v72, v62, v72
    v_pk_add_f16 v73, v63, v73
    ds_read_b32 v58, v53 offset:16224
    ds_read_b32 v59, v53 offset:16276
    ds_read_b32 v60, v54 offset:16224
    ds_read_b32 v61, v54 offset:16276
    ds_write_b32 v55, v72 offset:3264
    ds_write_b32 v55, v73 offset:3664
    s_branch L_wf5
L_wf4:
    s_sleep 1
L_wf5:
    ds_read_b32 v167, v165 offset:8
    s_waitcnt lgkmcnt(0)
    v_readfirstlane_b32 s40, v167
    s_cmp_lt_u32 s40, 12
    s_cbranch_scc1 L_wf4
    ds_read_b64_tr_b16 v[120:121], v15 offset:0
    ds_read_b64_tr_b16 v[122:123], v15 offset:128
    ds_read_b64_tr_b16 v[124:125], v15 offset:256
    ds_read_b64_tr_b16 v[126:127], v15 offset:384
    ds_read_b64_tr_b16 v[128:129], v15 offset:512
    ds_read_b64_tr_b16 v[130:131], v15 offset:640
    ds_read_b64_tr_b16 v[132:133], v15 offset:768
    ds_read_b64_tr_b16 v[134:135], v15 offset:1664
    ds_read_b64_tr_b16 v[136:137], v15 offset:1792
    ds_read_b64_tr_b16 v[138:139], v15 offset:1920
    ds_read_b64_tr_b16 v[140:141], v15 offset:2048
    ds_read_b64_tr_b16 v[142:143], v15 offset:2176
    ds_read_b64_tr_b16 v[144:145], v15 offset:2304
    ds_read_b64_tr_b16 v[146:147], v15 offset:2432
    v_perm_b32 v70, v69, v68, v56
    v_perm_b32 v71, v69, v68, v57
    v_pk_add_f16 v70, v66, v70
    v_pk_add_f16 v71, v67, v71
    ds_read_b32 v62, v53 offset:21632
    ds_read_b32 v63, v53 offset:21684
    ds_read_b32 v64, v54 offset:21632
    ds_read_b32 v65, v54 offset:21684
    ds_write_b32 v55, v70 offset:6528
    ds_write_b32 v55, v71 offset:6928
    v_perm_b32 v72, v61, v60, v56
    v_perm_b32 v73, v61, v60, v57
    v_pk_add_f16 v72, v58, v72
    v_pk_add_f16 v73, v59, v73
    ds_read_b32 v66, v53 offset:27040
    ds_read_b32 v67, v53 offset:27092
    ds_read_b32 v68, v54 offset:27040
    ds_read_b32 v69, v54 offset:27092
    ds_write_b32 v55, v72 offset:9792
    ds_write_b32 v55, v73 offset:10192
    s_waitcnt lgkmcnt(15)
    v_lshlrev_b32 v8, 16, v120
    v_and_b32 v9, 0xffff0000, v120
    v_cvt_pk_f16_f32 v120, v8, v9
    v_lshlrev_b32 v10, 16, v121
    v_and_b32 v11, 0xffff0000, v121
    v_cvt_pk_f16_f32 v121, v10, v11
    v_lshlrev_b32 v8, 16, v122
    v_and_b32 v9, 0xffff0000, v122
    v_cvt_pk_f16_f32 v122, v8, v9
    v_lshlrev_b32 v10, 16, v123
    v_and_b32 v11, 0xffff0000, v123
    v_cvt_pk_f16_f32 v123, v10, v11
    v_lshlrev_b32 v8, 16, v124
    v_and_b32 v9, 0xffff0000, v124
    v_cvt_pk_f16_f32 v124, v8, v9
    v_lshlrev_b32 v10, 16, v125
    v_and_b32 v11, 0xffff0000, v125
    v_cvt_pk_f16_f32 v125, v10, v11
    v_lshlrev_b32 v8, 16, v126
    v_and_b32 v9, 0xffff0000, v126
    v_cvt_pk_f16_f32 v126, v8, v9
    v_lshlrev_b32 v10, 16, v127
    v_and_b32 v11, 0xffff0000, v127
    v_cvt_pk_f16_f32 v127, v10, v11
    v_lshlrev_b32 v8, 16, v128
    v_and_b32 v9, 0xffff0000, v128
    v_cvt_pk_f16_f32 v128, v8, v9
    v_lshlrev_b32 v10, 16, v129
    v_and_b32 v11, 0xffff0000, v129
    v_cvt_pk_f16_f32 v129, v10, v11
    v_lshlrev_b32 v8, 16, v130
    v_and_b32 v9, 0xffff0000, v130
    v_cvt_pk_f16_f32 v130, v8, v9
    v_lshlrev_b32 v10, 16, v131
    v_and_b32 v11, 0xffff0000, v131
    v_cvt_pk_f16_f32 v131, v10, v11
    v_lshlrev_b32 v8, 16, v132
    v_and_b32 v9, 0xffff0000, v132
    v_cvt_pk_f16_f32 v132, v8, v9
    v_mov_b32 v133, 0x3c003c00
    v_perm_b32 v104, v121, v120, v14
    v_perm_b32 v105, v123, v122, v14
    v_perm_b32 v106, v125, v124, v14
    v_perm_b32 v107, v127, v126, v14
    v_perm_b32 v108, v129, v128, v14
    v_perm_b32 v109, v131, v130, v14
    v_perm_b32 v110, v133, v132, v14
    v_mov_b32 v111, 0
    s_waitcnt lgkmcnt(8)
    v_perm_b32 v70, v65, v64, v56
    v_perm_b32 v71, v65, v64, v57
    v_pk_add_f16 v70, v62, v70
    v_pk_add_f16 v71, v63, v71
    ds_read_b32 v58, v53 offset:32448
    ds_read_b32 v59, v53 offset:32500
    ds_read_b32 v60, v54 offset:32448
    ds_read_b32 v61, v54 offset:32500
    ds_write_b32 v55, v70 offset:13056
    ds_write_b32 v55, v71 offset:13456
    s_waitcnt lgkmcnt(8)
    v_perm_b32 v72, v69, v68, v56
    v_perm_b32 v73, v69, v68, v57
    v_pk_add_f16 v72, v66, v72
    v_pk_add_f16 v73, v67, v73
    ds_write_b32 v55, v72 offset:16320
    ds_write_b32 v55, v73 offset:16720
    s_mov_b64 exec, 1
    ds_add_u32 v165, v166 offset:48
    s_mov_b64 exec, -1
    v_lshlrev_b32 v8, 16, v134
    v_and_b32 v9, 0xffff0000, v134
    v_cvt_pk_f16_f32 v134, v8, v9
    v_lshlrev_b32 v10, 16, v135
    v_and_b32 v11, 0xffff0000, v135
    v_cvt_pk_f16_f32 v135, v10, v11
    v_lshlrev_b32 v8, 16, v136
    v_and_b32 v9, 0xffff0000, v136
    v_cvt_pk_f16_f32 v136, v8, v9
    v_lshlrev_b32 v10, 16, v137
    v_and_b32 v11, 0xffff0000, v137
    v_cvt_pk_f16_f32 v137, v10, v11
    v_lshlrev_b32 v8, 16, v138
    v_and_b32 v9, 0xffff0000, v138
    v_cvt_pk_f16_f32 v138, v8, v9
    v_lshlrev_b32 v10, 16, v139
    v_and_b32 v11, 0xffff0000, v139
    v_cvt_pk_f16_f32 v139, v10, v11
    v_lshlrev_b32 v8, 16, v140
    v_and_b32 v9, 0xffff0000, v140
    v_cvt_pk_f16_f32 v140, v8, v9
    v_lshlrev_b32 v10, 16, v141
    v_and_b32 v11, 0xffff0000, v141
    v_cvt_pk_f16_f32 v141, v10, v11
    v_lshlrev_b32 v8, 16, v142
    v_and_b32 v9, 0xffff0000, v142
    v_cvt_pk_f16_f32 v142, v8, v9
    v_lshlrev_b32 v10, 16, v143
    v_and_b32 v11, 0xffff0000, v143
    v_cvt_pk_f16_f32 v143, v10, v11
    v_lshlrev_b32 v8, 16, v144
    v_and_b32 v9, 0xffff0000, v144
    v_cvt_pk_f16_f32 v144, v8, v9
    v_lshlrev_b32 v10, 16, v145
    v_and_b32 v11, 0xffff0000, v145
    v_cvt_pk_f16_f32 v145, v10, v11
    v_lshlrev_b32 v8, 16, v146
    v_and_b32 v9, 0xffff0000, v146
    v_cvt_pk_f16_f32 v146, v8, v9
    v_mov_b32 v147, 0x3c003c00
    v_perm_b32 v112, v135, v134, v14
    v_perm_b32 v113, v137, v136, v14
    v_perm_b32 v114, v139, v138, v14
    v_perm_b32 v115, v141, v140, v14
    v_perm_b32 v116, v143, v142, v14
    v_perm_b32 v117, v145, v144, v14
    v_perm_b32 v118, v147, v146, v14
    v_mov_b32 v119, 0
    s_waitcnt lgkmcnt(5)
    v_perm_b32 v70, v61, v60, v56
    v_perm_b32 v71, v61, v60, v57
    v_pk_add_f16 v70, v58, v70
    v_pk_add_f16 v71, v59, v71
    ds_write_b32 v55, v70 offset:19584
    ds_write_b32 v55, v71 offset:19984
    s_waitcnt lgkmcnt(0)
    s_mov_b64 exec, 1
    ds_add_u32 v165, v166 offset:4
    s_mov_b64 exec, -1
    s_branch L_wf7
L_wf6:
    s_sleep 1
L_wf7:
    ds_read_b32 v167, v165 offset:4
    s_waitcnt lgkmcnt(0)
    v_readfirstlane_b32 s40, v167
    s_cmp_lt_u32 s40, 8
    s_cbranch_scc1 L_wf6
    ds_read_b128 v[152:155], v2 offset:0
    ds_read_b128 v[156:159], v2 offset:16
    ds_read_b128 v[160:163], v2 offset:32
    v_pk_mul_f16 v80, v104, v120 op_sel:[0,0] op_sel_hi:[0,1]
    v_pk_mul_f16 v81, v104, v121 op_sel:[0,0] op_sel_hi:[0,1]
    v_pk_mul_f16 v82, v104, v122 op_sel:[0,0] op_sel_hi:[0,1]
    v_pk_mul_f16 v83, v104, v123 op_sel:[0,0] op_sel_hi:[0,1]
    v_pk_mul_f16 v84, v112, v134 op_sel:[0,0] op_sel_hi:[0,1]
    v_pk_mul_f16 v85, v112, v135 op_sel:[0,0] op_sel_hi:[0,1]
    v_pk_mul_f16 v86, v112, v136 op_sel:[0,0] op_sel_hi:[0,1]
    v_pk_mul_f16 v87, v112, v137 op_sel:[0,0] op_sel_hi:[0,1]
    s_waitcnt lgkmcnt(2)
    v_mfma_f32_32x32x16_f16 v[16:31], v[152:155], v[80:83], 0
    ds_read_b128 v[148:151], v2 offset:48
    v_pk_mul_f16 v80, v104, v124 op_sel:[0,0] op_sel_hi:[0,1]
    v_pk_mul_f16 v81, v104, v125 op_sel:[0,0] op_sel_hi:[0,1]
    v_pk_mul_f16 v82, v104, v126 op_sel:[0,0] op_sel_hi:[0,1]
    v_pk_mul_f16 v83, v104, v127 op_sel:[0,0] op_sel_hi:[0,1]
    v_mfma_f32_32x32x16_f16 v[32:47], v[152:155], v[84:87], 0
    v_pk_mul_f16 v84, v112, v138 op_sel:[0,0] op_sel_hi:[0,1]
    v_pk_mul_f16 v85, v112, v139 op_sel:[0,0] op_sel_hi:[0,1]
    v_pk_mul_f16 v86, v112, v140 op_sel:[0,0] op_sel_hi:[0,1]
    v_pk_mul_f16 v87, v112, v141 op_sel:[0,0] op_sel_hi:[0,1]
    s_waitcnt lgkmcnt(2)
    v_mfma_f32_32x32x16_f16 v[16:31], v[156:159], v[80:83], v[16:31]
    ds_read_b128 v[152:155], v2 offset:64
    v_pk_mul_f16 v80, v104, v128 op_sel:[0,0] op_sel_hi:[0,1]
    v_pk_mul_f16 v81, v104, v129 op_sel:[0,0] op_sel_hi:[0,1]
    v_pk_mul_f16 v82, v104, v130 op_sel:[0,0] op_sel_hi:[0,1]
    v_pk_mul_f16 v83, v104, v131 op_sel:[0,0] op_sel_hi:[0,1]
    v_mfma_f32_32x32x16_f16 v[32:47], v[156:159], v[84:87], v[32:47]
    v_pk_mul_f16 v84, v112, v142 op_sel:[0,0] op_sel_hi:[0,1]
    v_pk_mul_f16 v85, v112, v143 op_sel:[0,0] op_sel_hi:[0,1]
    v_pk_mul_f16 v86, v112, v144 op_sel:[0,0] op_sel_hi:[0,1]
    v_pk_mul_f16 v87, v112, v145 op_sel:[0,0] op_sel_hi:[0,1]
    s_waitcnt lgkmcnt(2)
    v_mfma_f32_32x32x16_f16 v[16:31], v[160:163], v[80:83], v[16:31]
    ds_read_b128 v[156:159], v2 offset:80
    v_pk_mul_f16 v80, v104, v132 op_sel:[0,0] op_sel_hi:[0,1]
    v_pk_mul_f16 v81, v104, v121 op_sel:[1,0] op_sel_hi:[1,1]
    v_pk_mul_f16 v82, v104, v122 op_sel:[1,0] op_sel_hi:[1,1]
    v_pk_mul_f16 v83, v104, v123 op_sel:[1,0] op_sel_hi:[1,1]
    v_mfma_f32_32x32x16_f16 v[32:47], v[160:163], v[84:87], v[32:47]
    v_pk_mul_f16 v84, v112, v146 op_sel:[0,0] op_sel_hi:[0,1]
    v_pk_mul_f16 v85, v112, v135 op_sel:[1,0] op_sel_hi:[1,1]
    v_pk_mul_f16 v86, v112, v136 op_sel:[1,0] op_sel_hi:[1,1]
    v_pk_mul_f16 v87, v112, v137 op_sel:[1,0] op_sel_hi:[1,1]
    s_waitcnt lgkmcnt(2)
    v_mfma_f32_32x32x16_f16 v[16:31], v[148:151], v[80:83], v[16:31]
    ds_read_b128 v[160:163], v2 offset:96
    v_pk_mul_f16 v80, v104, v124 op_sel:[1,0] op_sel_hi:[1,1]
    v_pk_mul_f16 v81, v104, v125 op_sel:[1,0] op_sel_hi:[1,1]
    v_pk_mul_f16 v82, v104, v126 op_sel:[1,0] op_sel_hi:[1,1]
    v_pk_mul_f16 v83, v104, v127 op_sel:[1,0] op_sel_hi:[1,1]
    v_mfma_f32_32x32x16_f16 v[32:47], v[148:151], v[84:87], v[32:47]
    v_pk_mul_f16 v84, v112, v138 op_sel:[1,0] op_sel_hi:[1,1]
    v_pk_mul_f16 v85, v112, v139 op_sel:[1,0] op_sel_hi:[1,1]
    v_pk_mul_f16 v86, v112, v140 op_sel:[1,0] op_sel_hi:[1,1]
    v_pk_mul_f16 v87, v112, v141 op_sel:[1,0] op_sel_hi:[1,1]
    s_waitcnt lgkmcnt(2)
    v_mfma_f32_32x32x16_f16 v[16:31], v[152:155], v[80:83], v[16:31]
    ds_read_b128 v[148:151], v2 offset:112
    v_pk_mul_f16 v80, v104, v128 op_sel:[1,0] op_sel_hi:[1,1]
    v_pk_mul_f16 v81, v104, v129 op_sel:[1,0] op_sel_hi:[1,1]
    v_pk_mul_f16 v82, v104, v130 op_sel:[1,0] op_sel_hi:[1,1]
    v_pk_mul_f16 v83, v104, v131 op_sel:[1,0] op_sel_hi:[1,1]
    v_mfma_f32_32x32x16_f16 v[32:47], v[152:155], v[84:87], v[32:47]
    v_pk_mul_f16 v84, v112, v142 op_sel:[1,0] op_sel_hi:[1,1]
    v_pk_mul_f16 v85, v112, v143 op_sel:[1,0] op_sel_hi:[1,1]
    v_pk_mul_f16 v86, v112, v144 op_sel:[1,0] op_sel_hi:[1,1]
    v_pk_mul_f16 v87, v112, v145 op_sel:[1,0] op_sel_hi:[1,1]
    s_waitcnt lgkmcnt(2)
    v_mfma_f32_32x32x16_f16 v[16:31], v[156:159], v[80:83], v[16:31]
    ds_read_b128 v[152:155], v2 offset:128
    v_pk_mul_f16 v80, v104, v132 op_sel:[1,0] op_sel_hi:[1,1]
    v_pk_mul_f16 v81, v105, v122 op_sel:[0,0] op_sel_hi:[0,1]
    v_pk_mul_f16 v82, v105, v123 op_sel:[0,0] op_sel_hi:[0,1]
    v_pk_mul_f16 v83, v105, v124 op_sel:[0,0] op_sel_hi:[0,1]
    v_mfma_f32_32x32x16_f16 v[32:47], v[156:159], v[84:87], v[32:47]
    v_pk_mul_f16 v84, v112, v146 op_sel:[1,0] op_sel_hi:[1,1]
    v_pk_mul_f16 v85, v113, v136 op_sel:[0,0] op_sel_hi:[0,1]
    v_pk_mul_f16 v86, v113, v137 op_sel:[0,0] op_sel_hi:[0,1]
    v_pk_mul_f16 v87, v113, v138 op_sel:[0,0] op_sel_hi:[0,1]
    s_waitcnt lgkmcnt(2)
    v_mfma_f32_32x32x16_f16 v[16:31], v[160:163], v[80:83], v[16:31]
    ds_read_b128 v[156:159], v2 offset:144
    v_pk_mul_f16 v80, v105, v125 op_sel:[0,0] op_sel_hi:[0,1]
    v_pk_mul_f16 v81, v105, v126 op_sel:[0,0] op_sel_hi:[0,1]
    v_pk_mul_f16 v82, v105, v127 op_sel:[0,0] op_sel_hi:[0,1]
    v_pk_mul_f16 v83, v105, v128 op_sel:[0,0] op_sel_hi:[0,1]
    v_mfma_f32_32x32x16_f16 v[32:47], v[160:163], v[84:87], v[32:47]
    v_pk_mul_f16 v84, v113, v139 op_sel:[0,0] op_sel_hi:[0,1]
    v_pk_mul_f16 v85, v113, v140 op_sel:[0,0] op_sel_hi:[0,1]
    v_pk_mul_f16 v86, v113, v141 op_sel:[0,0] op_sel_hi:[0,1]
    v_pk_mul_f16 v87, v113, v142 op_sel:[0,0] op_sel_hi:[0,1]
    s_waitcnt lgkmcnt(2)
    v_mfma_f32_32x32x16_f16 v[16:31], v[148:151], v[80:83], v[16:31]
    ds_read_b128 v[160:163], v2 offset:160
    v_pk_mul_f16 v80, v105, v129 op_sel:[0,0] op_sel_hi:[0,1]
    v_pk_mul_f16 v81, v105, v130 op_sel:[0,0] op_sel_hi:[0,1]
    v_pk_mul_f16 v82, v105, v131 op_sel:[0,0] op_sel_hi:[0,1]
    v_pk_mul_f16 v83, v105, v132 op_sel:[0,0] op_sel_hi:[0,1]
    v_mfma_f32_32x32x16_f16 v[32:47], v[148:151], v[84:87], v[32:47]
    v_pk_mul_f16 v84, v113, v143 op_sel:[0,0] op_sel_hi:[0,1]
    v_pk_mul_f16 v85, v113, v144 op_sel:[0,0] op_sel_hi:[0,1]
    v_pk_mul_f16 v86, v113, v145 op_sel:[0,0] op_sel_hi:[0,1]
    v_pk_mul_f16 v87, v113, v146 op_sel:[0,0] op_sel_hi:[0,1]
    s_waitcnt lgkmcnt(2)
    v_mfma_f32_32x32x16_f16 v[16:31], v[152:155], v[80:83], v[16:31]
    ds_read_b128 v[148:151], v2 offset:176
    v_pk_mul_f16 v80, v105, v123 op_sel:[1,0] op_sel_hi:[1,1]
    v_pk_mul_f16 v81, v105, v124 op_sel:[1,0] op_sel_hi:[1,1]
    v_pk_mul_f16 v82, v105, v125 op_sel:[1,0] op_sel_hi:[1,1]
    v_pk_mul_f16 v83, v105, v126 op_sel:[1,0] op_sel_hi:[1,1]
    v_mfma_f32_32x32x16_f16 v[32:47], v[152:155], v[84:87], v[32:47]
    v_pk_mul_f16 v84, v113, v137 op_sel:[1,0] op_sel_hi:[1,1]
    v_pk_mul_f16 v85, v113, v138 op_sel:[1,0] op_sel_hi:[1,1]
    v_pk_mul_f16 v86, v113, v139 op_sel:[1,0] op_sel_hi:[1,1]
    v_pk_mul_f16 v87, v113, v140 op_sel:[1,0] op_sel_hi:[1,1]
    s_waitcnt lgkmcnt(2)
    v_mfma_f32_32x32x16_f16 v[16:31], v[156:159], v[80:83], v[16:31]
    ds_read_b128 v[152:155], v2 offset:192
    v_pk_mul_f16 v80, v105, v127 op_sel:[1,0] op_sel_hi:[1,1]
    v_pk_mul_f16 v81, v105, v128 op_sel:[1,0] op_sel_hi:[1,1]
    v_pk_mul_f16 v82, v105, v129 op_sel:[1,0] op_sel_hi:[1,1]
    v_pk_mul_f16 v83, v105, v130 op_sel:[1,0] op_sel_hi:[1,1]
    v_mfma_f32_32x32x16_f16 v[32:47], v[156:159], v[84:87], v[32:47]
    v_pk_mul_f16 v84, v113, v141 op_sel:[1,0] op_sel_hi:[1,1]
    v_pk_mul_f16 v85, v113, v142 op_sel:[1,0] op_sel_hi:[1,1]
    v_pk_mul_f16 v86, v113, v143 op_sel:[1,0] op_sel_hi:[1,1]
    v_pk_mul_f16 v87, v113, v144 op_sel:[1,0] op_sel_hi:[1,1]
    s_waitcnt lgkmcnt(2)
    v_mfma_f32_32x32x16_f16 v[16:31], v[160:163], v[80:83], v[16:31]
    ds_read_b128 v[156:159], v2 offset:208
    v_pk_mul_f16 v80, v105, v131 op_sel:[1,0] op_sel_hi:[1,1]
    v_pk_mul_f16 v81, v105, v132 op_sel:[1,0] op_sel_hi:[1,1]
    v_pk_mul_f16 v82, v106, v124 op_sel:[0,0] op_sel_hi:[0,1]
    v_pk_mul_f16 v83, v106, v125 op_sel:[0,0] op_sel_hi:[0,1]
    v_mfma_f32_32x32x16_f16 v[32:47], v[160:163], v[84:87], v[32:47]
    v_pk_mul_f16 v84, v113, v145 op_sel:[1,0] op_sel_hi:[1,1]
    v_pk_mul_f16 v85, v113, v146 op_sel:[1,0] op_sel_hi:[1,1]
    v_pk_mul_f16 v86, v114, v138 op_sel:[0,0] op_sel_hi:[0,1]
    v_pk_mul_f16 v87, v114, v139 op_sel:[0,0] op_sel_hi:[0,1]
    s_waitcnt lgkmcnt(2)
    v_mfma_f32_32x32x16_f16 v[16:31], v[148:151], v[80:83], v[16:31]
    ds_read_b128 v[160:163], v2 offset:224
    v_pk_mul_f16 v80, v106, v126 op_sel:[0,0] op_sel_hi:[0,1]
    v_pk_mul_f16 v81, v106, v127 op_sel:[0,0] op_sel_hi:[0,1]
    v_pk_mul_f16 v82, v106, v128 op_sel:[0,0] op_sel_hi:[0,1]
    v_pk_mul_f16 v83, v106, v129 op_sel:[0,0] op_sel_hi:[0,1]
    v_mfma_f32_32x32x16_f16 v[32:47], v[148:151], v[84:87], v[32:47]
    v_pk_mul_f16 v84, v114, v140 op_sel:[0,0] op_sel_hi:[0,1]
    v_pk_mul_f16 v85, v114, v141 op_sel:[0,0] op_sel_hi:[0,1]
    v_pk_mul_f16 v86, v114, v142 op_sel:[0,0] op_sel_hi:[0,1]
    v_pk_mul_f16 v87, v114, v143 op_sel:[0,0] op_sel_hi:[0,1]
    s_waitcnt lgkmcnt(2)
    v_mfma_f32_32x32x16_f16 v[16:31], v[152:155], v[80:83], v[16:31]
    ds_read_b128 v[148:151], v2 offset:240
    v_pk_mul_f16 v80, v106, v130 op_sel:[0,0] op_sel_hi:[0,1]
    v_pk_mul_f16 v81, v106, v131 op_sel:[0,0] op_sel_hi:[0,1]
    v_pk_mul_f16 v82, v106, v132 op_sel:[0,0] op_sel_hi:[0,1]
    v_pk_mul_f16 v83, v106, v125 op_sel:[1,0] op_sel_hi:[1,1]
    v_mfma_f32_32x32x16_f16 v[32:47], v[152:155], v[84:87], v[32:47]
    v_pk_mul_f16 v84, v114, v144 op_sel:[0,0] op_sel_hi:[0,1]
    v_pk_mul_f16 v85, v114, v145 op_sel:[0,0] op_sel_hi:[0,1]
    v_pk_mul_f16 v86, v114, v146 op_sel:[0,0] op_sel_hi:[0,1]
    v_pk_mul_f16 v87, v114, v139 op_sel:[1,0] op_sel_hi:[1,1]
    s_waitcnt lgkmcnt(2)
    v_mfma_f32_32x32x16_f16 v[16:31], v[156:159], v[80:83], v[16:31]
    ds_read_b128 v[152:155], v2 offset:256
    v_pk_mul_f16 v80, v106, v126 op_sel:[1,0] op_sel_hi:[1,1]
    v_pk_mul_f16 v81, v106, v127 op_sel:[1,0] op_sel_hi:[1,1]
    v_pk_mul_f16 v82, v106, v128 op_sel:[1,0] op_sel_hi:[1,1]
    v_pk_mul_f16 v83, v106, v129 op_sel:[1,0] op_sel_hi:[1,1]
    v_mfma_f32_32x32x16_f16 v[32:47], v[156:159], v[84:87], v[32:47]
    v_pk_mul_f16 v84, v114, v140 op_sel:[1,0] op_sel_hi:[1,1]
    v_pk_mul_f16 v85, v114, v141 op_sel:[1,0] op_sel_hi:[1,1]
    v_pk_mul_f16 v86, v114, v142 op_sel:[1,0] op_sel_hi:[1,1]
    v_pk_mul_f16 v87, v114, v143 op_sel:[1,0] op_sel_hi:[1,1]
    s_waitcnt lgkmcnt(2)
    v_mfma_f32_32x32x16_f16 v[16:31], v[160:163], v[80:83], v[16:31]
    ds_read_b128 v[156:159], v2 offset:272
    v_pk_mul_f16 v80, v106, v130 op_sel:[1,0] op_sel_hi:[1,1]
    v_pk_mul_f16 v81, v106, v131 op_sel:[1,0] op_sel_hi:[1,1]
    v_pk_mul_f16 v82, v106, v132 op_sel:[1,0] op_sel_hi:[1,1]
    v_pk_mul_f16 v83, v107, v126 op_sel:[0,0] op_sel_hi:[0,1]
    v_mfma_f32_32x32x16_f16 v[32:47], v[160:163], v[84:87], v[32:47]
    v_pk_mul_f16 v84, v114, v144 op_sel:[1,0] op_sel_hi:[1,1]
    v_pk_mul_f16 v85, v114, v145 op_sel:[1,0] op_sel_hi:[1,1]
    v_pk_mul_f16 v86, v114, v146 op_sel:[1,0] op_sel_hi:[1,1]
    v_pk_mul_f16 v87, v115, v140 op_sel:[0,0] op_sel_hi:[0,1]
    s_waitcnt lgkmcnt(2)
    v_mfma_f32_32x32x16_f16 v[16:31], v[148:151], v[80:83], v[16:31]
    ds_read_b128 v[160:163], v2 offset:288
    v_pk_mul_f16 v80, v107, v127 op_sel:[0,0] op_sel_hi:[0,1]
    v_pk_mul_f16 v81, v107, v128 op_sel:[0,0] op_sel_hi:[0,1]
    v_pk_mul_f16 v82, v107, v129 op_sel:[0,0] op_sel_hi:[0,1]
    v_pk_mul_f16 v83, v107, v130 op_sel:[0,0] op_sel_hi:[0,1]
    v_mfma_f32_32x32x16_f16 v[32:47], v[148:151], v[84:87], v[32:47]
    v_pk_mul_f16 v84, v115, v141 op_sel:[0,0] op_sel_hi:[0,1]
    v_pk_mul_f16 v85, v115, v142 op_sel:[0,0] op_sel_hi:[0,1]
    v_pk_mul_f16 v86, v115, v143 op_sel:[0,0] op_sel_hi:[0,1]
    v_pk_mul_f16 v87, v115, v144 op_sel:[0,0] op_sel_hi:[0,1]
    s_waitcnt lgkmcnt(2)
    v_mfma_f32_32x32x16_f16 v[16:31], v[152:155], v[80:83], v[16:31]
    ds_read_b128 v[148:151], v2 offset:304
    v_pk_mul_f16 v80, v107, v131 op_sel:[0,0] op_sel_hi:[0,1]
    v_pk_mul_f16 v81, v107, v132 op_sel:[0,0] op_sel_hi:[0,1]
    v_pk_mul_f16 v82, v107, v127 op_sel:[1,0] op_sel_hi:[1,1]
    v_pk_mul_f16 v83, v107, v128 op_sel:[1,0] op_sel_hi:[1,1]
    v_mfma_f32_32x32x16_f16 v[32:47], v[152:155], v[84:87], v[32:47]
    v_pk_mul_f16 v84, v115, v145 op_sel:[0,0] op_sel_hi:[0,1]
    v_pk_mul_f16 v85, v115, v146 op_sel:[0,0] op_sel_hi:[0,1]
    v_pk_mul_f16 v86, v115, v141 op_sel:[1,0] op_sel_hi:[1,1]
    v_pk_mul_f16 v87, v115, v142 op_sel:[1,0] op_sel_hi:[1,1]
    s_waitcnt lgkmcnt(2)
    v_mfma_f32_32x32x16_f16 v[16:31], v[156:159], v[80:83], v[16:31]
    ds_read_b128 v[152:155], v2 offset:320
    ds_read_b32 v167, v165 offset:12
    v_pk_mul_f16 v80, v107, v129 op_sel:[1,0] op_sel_hi:[1,1]
    v_pk_mul_f16 v81, v107, v130 op_sel:[1,0] op_sel_hi:[1,1]
    v_pk_mul_f16 v82, v107, v131 op_sel:[1,0] op_sel_hi:[1,1]
    v_pk_mul_f16 v83, v107, v132 op_sel:[1,0] op_sel_hi:[1,1]
    v_mfma_f32_32x32x16_f16 v[32:47], v[156:159], v[84:87], v[32:47]
    v_pk_mul_f16 v84, v115, v143 op_sel:[1,0] op_sel_hi:[1,1]
    v_pk_mul_f16 v85, v115, v144 op_sel:[1,0] op_sel_hi:[1,1]
    v_pk_mul_f16 v86, v115, v145 op_sel:[1,0] op_sel_hi:[1,1]
    v_pk_mul_f16 v87, v115, v146 op_sel:[1,0] op_sel_hi:[1,1]
    s_waitcnt lgkmcnt(3)
    v_mfma_f32_32x32x16_f16 v[16:31], v[160:163], v[80:83], v[16:31]
    ds_read_b128 v[156:159], v2 offset:336
    v_pk_mul_f16 v80, v108, v128 op_sel:[0,0] op_sel_hi:[0,1]
    v_pk_mul_f16 v81, v108, v129 op_sel:[0,0] op_sel_hi:[0,1]
    v_pk_mul_f16 v82, v108, v130 op_sel:[0,0] op_sel_hi:[0,1]
    v_pk_mul_f16 v83, v108, v131 op_sel:[0,0] op_sel_hi:[0,1]
    v_mfma_f32_32x32x16_f16 v[32:47], v[160:163], v[84:87], v[32:47]
    v_pk_mul_f16 v84, v116, v142 op_sel:[0,0] op_sel_hi:[0,1]
    v_pk_mul_f16 v85, v116, v143 op_sel:[0,0] op_sel_hi:[0,1]
    v_pk_mul_f16 v86, v116, v144 op_sel:[0,0] op_sel_hi:[0,1]
    v_pk_mul_f16 v87, v116, v145 op_sel:[0,0] op_sel_hi:[0,1]
    s_waitcnt lgkmcnt(3)
    v_mfma_f32_32x32x16_f16 v[16:31], v[148:151], v[80:83], v[16:31]
    ds_read_b128 v[160:163], v2 offset:352
    v_pk_mul_f16 v80, v108, v132 op_sel:[0,0] op_sel_hi:[0,1]
    v_pk_mul_f16 v81, v108, v129 op_sel:[1,0] op_sel_hi:[1,1]
    v_pk_mul_f16 v82, v108, v130 op_sel:[1,0] op_sel_hi:[1,1]
    v_pk_mul_f16 v83, v108, v131 op_sel:[1,0] op_sel_hi:[1,1]
    v_mfma_f32_32x32x16_f16 v[32:47], v[148:151], v[84:87], v[32:47]
    v_pk_mul_f16 v84, v116, v146 op_sel:[0,0] op_sel_hi:[0,1]
    v_pk_mul_f16 v85, v116, v143 op_sel:[1,0] op_sel_hi:[1,1]
    v_pk_mul_f16 v86, v116, v144 op_sel:[1,0] op_sel_hi:[1,1]
    v_pk_mul_f16 v87, v116, v145 op_sel:[1,0] op_sel_hi:[1,1]
    s_waitcnt lgkmcnt(3)
    v_mfma_f32_32x32x16_f16 v[16:31], v[152:155], v[80:83], v[16:31]
    s_waitcnt lgkmcnt(2)
    v_readfirstlane_b32 s40, v167
    s_cmp_ge_u32 s40, 4
    s_cbranch_scc1 L_wfok8
    s_branch L_wf10
L_wf9:
    s_sleep 1
L_wf10:
    ds_read_b32 v167, v165 offset:12
    s_waitcnt lgkmcnt(0)
    v_readfirstlane_b32 s40, v167
    s_cmp_lt_u32 s40, 4
    s_cbranch_scc1 L_wf9
L_wfok8:
    ds_read_b128 v[148:151], v12 offset:0
    v_pk_mul_f16 v80, v108, v132 op_sel:[1,0] op_sel_hi:[1,1]
    v_pk_mul_f16 v81, v109, v130 op_sel:[0,0] op_sel_hi:[0,1]
    v_pk_mul_f16 v82, v109, v131 op_sel:[0,0] op_sel_hi:[0,1]
    v_pk_mul_f16 v83, v109, v132 op_sel:[0,0] op_sel_hi:[0,1]
    v_mfma_f32_32x32x16_f16 v[32:47], v[152:155], v[84:87], v[32:47]
    v_pk_mul_f16 v84, v116, v146 op_sel:[1,0] op_sel_hi:[1,1]
    v_pk_mul_f16 v85, v117, v144 op_sel:[0,0] op_sel_hi:[0,1]
    v_pk_mul_f16 v86, v117, v145 op_sel:[0,0] op_sel_hi:[0,1]
    v_pk_mul_f16 v87, v117, v146 op_sel:[0,0] op_sel_hi:[0,1]
    s_waitcnt lgkmcnt(2)
    v_mfma_f32_32x32x16_f16 v[16:31], v[156:159], v[80:83], v[16:31]
    ds_read_b128 v[152:155], v12 offset:16
    v_pk_mul_f16 v80, v109, v131 op_sel:[1,0] op_sel_hi:[1,1]
    v_pk_mul_f16 v81, v109, v132 op_sel:[1,0] op_sel_hi:[1,1]
    v_pk_mul_f16 v82, v110, v132 op_sel:[0,0] op_sel_hi:[0,1]
    v_mov_b32 v83, 0
    v_mfma_f32_32x32x16_f16 v[32:47], v[156:159], v[84:87], v[32:47]
    v_pk_mul_f16 v84, v117, v145 op_sel:[1,0] op_sel_hi:[1,1]
    v_pk_mul_f16 v85, v117, v146 op_sel:[1,0] op_sel_hi:[1,1]
    v_pk_mul_f16 v86, v118, v146 op_sel:[0,0] op_sel_hi:[0,1]
    v_mov_b32 v87, 0
    s_waitcnt lgkmcnt(2)
    v_mfma_f32_32x32x16_f16 v[16:31], v[160:163], v[80:83], v[16:31]
    ds_read_b128 v[156:159], v12 offset:32
    s_mov_b64 exec, 1
    ds_add_u32 v165, v166 offset:16
    s_mov_b64 exec, -1
    v_mfma_f32_32x32x16_f16 v[32:47], v[160:163], v[84:87], v[32:47]
    v_add_u32 v2, 21216, v2
    s_mov_b32 s42, 0
    s_mov_b32 s43, 4294928848
    s_mov_b32 s47, 8
    v_add_u32 v12, s43, v3
    s_nop 6
    v_cvt_pk_f16_f32 v89, v16, v17
    v_cvt_pk_f16_f32 v90, v18, v19
    v_cvt_pk_f16_f32 v91, v20, v21
    v_cvt_pk_f16_f32 v92, v22, v23
    v_cvt_pk_f16_f32 v93, v24, v25
    v_cvt_pk_f16_f32 v94, v26, v27
    v_cvt_pk_f16_f32 v95, v28, 0
    v_pk_mul_f16 v80, v89, v120 op_sel:[0,0] op_sel_hi:[0,1]
    v_pk_mul_f16 v81, v89, v121 op_sel:[0,0] op_sel_hi:[0,1]
    v_pk_mul_f16 v82, v89, v122 op_sel:[0,0] op_sel_hi:[0,1]
    v_pk_mul_f16 v83, v89, v123 op_sel:[0,0] op_sel_hi:[0,1]
    v_max3_f32 v8, abs(v16), abs(v17), abs(v18)
    v_max3_f32 v8, abs(v19), abs(v20), v8
    v_min_f32 v7, v7, v8
    v_cvt_pk_f16_f32 v97, v32, v33
    v_cvt_pk_f16_f32 v98, v34, v35
    v_cvt_pk_f16_f32 v99, v36, v37
    v_cvt_pk_f16_f32 v100, v38, v39
    v_cvt_pk_f16_f32 v101, v40, v41
    v_cvt_pk_f16_f32 v102, v42, v43
    v_cvt_pk_f16_f32 v103, v44, 0
    v_pk_mul_f16 v84, v97, v134 op_sel:[0,0] op_sel_hi:[0,1]
    v_pk_mul_f16 v85, v97, v135 op_sel:[0,0] op_sel_hi:[0,1]
    v_pk_mul_f16 v86, v97, v136 op_sel:[0,0] op_sel_hi:[0,1]
    v_pk_mul_f16 v87, v97, v137 op_sel:[0,0] op_sel_hi:[0,1]
    v_max3_f32 v8, abs(v32), abs(v33), abs(v34)
    v_max3_f32 v8, abs(v35), abs(v36), v8
    v_min_f32 v7, v7, v8
    s_waitcnt lgkmcnt(0)
L_layer:
    v_mfma_f32_32x32x16_f16 v[16:31], v[148:151], v[80:83], 0
    ds_read_b128 v[160:163], v3 offset:48
    v_pk_mul_f16 v80, v89, v124 op_sel:[0,0] op_sel_hi:[0,1]
    v_pk_mul_f16 v81, v89, v125 op_sel:[0,0] op_sel_hi:[0,1]
    v_pk_mul_f16 v82, v89, v126 op_sel:[0,0] op_sel_hi:[0,1]
    v_pk_mul_f16 v83, v89, v127 op_sel:[0,0] op_sel_hi:[0,1]
    v_mfma_f32_32x32x16_f16 v[32:47], v[148:151], v[84:87], 0
    v_pk_mul_f16 v84, v97, v138 op_sel:[0,0] op_sel_hi:[0,1]
    v_pk_mul_f16 v85, v97, v139 op_sel:[0,0] op_sel_hi:[0,1]
    v_pk_mul_f16 v86, v97, v140 op_sel:[0,0] op_sel_hi:[0,1]
    v_pk_mul_f16 v87, v97, v141 op_sel:[0,0] op_sel_hi:[0,1]
    v_mfma_f32_32x32x16_f16 v[16:31], v[152:155], v[80:83], v[16:31]
    ds_read_b128 v[148:151], v3 offset:64
    v_pk_mul_f16 v80, v89, v128 op_sel:[0,0] op_sel_hi:[0,1]
    v_pk_mul_f16 v81, v89, v129 op_sel:[0,0] op_sel_hi:[0,1]
    v_pk_mul_f16 v82, v89, v130 op_sel:[0,0] op_sel_hi:[0,1]
    v_pk_mul_f16 v83, v89, v131 op_sel:[0,0] op_sel_hi:[0,1]
    v_mfma_f32_32x32x16_f16 v[32:47], v[152:155], v[84:87], v[32:47]
    v_pk_mul_f16 v84, v97, v142 op_sel:[0,0] op_sel_hi:[0,1]
    v_pk_mul_f16 v85, v97, v143 op_sel:[0,0] op_sel_hi:[0,1]
    v_pk_mul_f16 v86, v97, v144 op_sel:[0,0] op_sel_hi:[0,1]
    v_pk_mul_f16 v87, v97, v145 op_sel:[0,0] op_sel_hi:[0,1]
    v_mfma_f32_32x32x16_f16 v[16:31], v[156:159], v[80:83], v[16:31]
    ds_read_b128 v[152:155], v3 offset:80
    v_pk_mul_f16 v80, v89, v132 op_sel:[0,0] op_sel_hi:[0,1]
    v_pk_mul_f16 v81, v89, v120 op_sel:[1,0] op_sel_hi:[1,1]
    v_pk_mul_f16 v82, v89, v121 op_sel:[1,0] op_sel_hi:[1,1]
    v_pk_mul_f16 v83, v89, v122 op_sel:[1,0] op_sel_hi:[1,1]
    v_mfma_f32_32x32x16_f16 v[32:47], v[156:159], v[84:87], v[32:47]
    v_pk_mul_f16 v84, v97, v146 op_sel:[0,0] op_sel_hi:[0,1]
    v_pk_mul_f16 v85, v97, v134 op_sel:[1,0] op_sel_hi:[1,1]
    v_pk_mul_f16 v86, v97, v135 op_sel:[1,0] op_sel_hi:[1,1]
    v_pk_mul_f16 v87, v97, v136 op_sel:[1,0] op_sel_hi:[1,1]
    s_waitcnt lgkmcnt(2)
    v_mfma_f32_32x32x16_f16 v[16:31], v[160:163], v[80:83], v[16:31]
    ds_read_b128 v[156:159], v3 offset:96
    v_pk_mul_f16 v80, v89, v123 op_sel:[1,0] op_sel_hi:[1,1]
    v_pk_mul_f16 v81, v89, v124 op_sel:[1,0] op_sel_hi:[1,1]
    v_pk_mul_f16 v82, v89, v125 op_sel:[1,0] op_sel_hi:[1,1]
    v_pk_mul_f16 v83, v89, v126 op_sel:[1,0] op_sel_hi:[1,1]
    v_mfma_f32_32x32x16_f16 v[32:47], v[160:163], v[84:87], v[32:47]
    v_pk_mul_f16 v84, v97, v137 op_sel:[1,0] op_sel_hi:[1,1]
    v_pk_mul_f16 v85, v97, v138 op_sel:[1,0] op_sel_hi:[1,1]
    v_pk_mul_f16 v86, v97, v139 op_sel:[1,0] op_sel_hi:[1,1]
    v_pk_mul_f16 v87, v97, v140 op_sel:[1,0] op_sel_hi:[1,1]
    s_waitcnt lgkmcnt(2)
    v_mfma_f32_32x32x16_f16 v[16:31], v[148:151], v[80:83], v[16:31]
    ds_read_b128 v[160:163], v3 offset:112
    v_pk_mul_f16 v80, v89, v127 op_sel:[1,0] op_sel_hi:[1,1]
    v_pk_mul_f16 v81, v89, v128 op_sel:[1,0] op_sel_hi:[1,1]
    v_pk_mul_f16 v82, v89, v129 op_sel:[1,0] op_sel_hi:[1,1]
    v_pk_mul_f16 v83, v89, v130 op_sel:[1,0] op_sel_hi:[1,1]
    v_mfma_f32_32x32x16_f16 v[32:47], v[148:151], v[84:87], v[32:47]
    v_pk_mul_f16 v84, v97, v141 op_sel:[1,0] op_sel_hi:[1,1]
    v_pk_mul_f16 v85, v97, v142 op_sel:[1,0] op_sel_hi:[1,1]
    v_pk_mul_f16 v86, v97, v143 op_sel:[1,0] op_sel_hi:[1,1]
    v_pk_mul_f16 v87, v97, v144 op_sel:[1,0] op_sel_hi:[1,1]
    s_waitcnt lgkmcnt(2)
    v_mfma_f32_32x32x16_f16 v[16:31], v[152:155], v[80:83], v[16:31]
    ds_read_b128 v[148:151], v3 offset:128
    v_pk_mul_f16 v80, v89, v131 op_sel:[1,0] op_sel_hi:[1,1]
    v_pk_mul_f16 v81, v89, v132 op_sel:[1,0] op_sel_hi:[1,1]
    v_pk_mul_f16 v82, v90, v120 op_sel:[0,0] op_sel_hi:[0,1]
    v_pk_mul_f16 v83, v90, v121 op_sel:[0,0] op_sel_hi:[0,1]
    v_mfma_f32_32x32x16_f16 v[32:47], v[152:155], v[84:87], v[32:47]
    v_pk_mul_f16 v84, v97, v145 op_sel:[1,0] op_sel_hi:[1,1]
    v_pk_mul_f16 v85, v97, v146 op_sel:[1,0] op_sel_hi:[1,1]
    v_pk_mul_f16 v86, v98, v134 op_sel:[0,0] op_sel_hi:[0,1]
    v_pk_mul_f16 v87, v98, v135 op_sel:[0,0] op_sel_hi:[0,1]
    s_waitcnt lgkmcnt(2)
    v_mfma_f32_32x32x16_f16 v[16:31], v[156:159], v[80:83], v[16:31]
    ds_read_b128 v[152:155], v3 offset:144
    v_pk_mul_f16 v80, v90, v122 op_sel:[0,0] op_sel_hi:[0,1]
    v_pk_mul_f16 v81, v90, v123 op_sel:[0,0] op_sel_hi:[0,1]
    v_pk_mul_f16 v82, v90, v124 op_sel:[0,0] op_sel_hi:[0,1]
    v_pk_mul_f16 v83, v90, v125 op_sel:[0,0] op_sel_hi:[0,1]
    v_mfma_f32_32x32x16_f16 v[32:47], v[156:159], v[84:87], v[32:47]
    v_pk_mul_f16 v84, v98, v136 op_sel:[0,0] op_sel_hi:[0,1]
    v_pk_mul_f16 v85, v98, v137 op_sel:[0,0] op_sel_hi:[0,1]
    v_pk_mul_f16 v86, v98, v138 op_sel:[0,0] op_sel_hi:[0,1]
    v_pk_mul_f16 v87, v98, v139 op_sel:[0,0] op_sel_hi:[0,1]
    s_waitcnt lgkmcnt(2)
    v_mfma_f32_32x32x16_f16 v[16:31], v[160:163], v[80:83], v[16:31]
    ds_read_b128 v[156:159], v3 offset:160
    v_pk_mul_f16 v80, v90, v126 op_sel:[0,0] op_sel_hi:[0,1]
    v_pk_mul_f16 v81, v90, v127 op_sel:[0,0] op_sel_hi:[0,1]
    v_pk_mul_f16 v82, v90, v128 op_sel:[0,0] op_sel_hi:[0,1]
    v_pk_mul_f16 v83, v90, v129 op_sel:[0,0] op_sel_hi:[0,1]
    v_mfma_f32_32x32x16_f16 v[32:47], v[160:163], v[84:87], v[32:47]
    v_pk_mul_f16 v84, v98, v140 op_sel:[0,0] op_sel_hi:[0,1]
    v_pk_mul_f16 v85, v98, v141 op_sel:[0,0] op_sel_hi:[0,1]
    v_pk_mul_f16 v86, v98, v142 op_sel:[0,0] op_sel_hi:[0,1]
    v_pk_mul_f16 v87, v98, v143 op_sel:[0,0] op_sel_hi:[0,1]
    s_waitcnt lgkmcnt(2)
    v_mfma_f32_32x32x16_f16 v[16:31], v[148:151], v[80:83], v[16:31]
    ds_read_b128 v[160:163], v3 offset:176
    v_pk_mul_f16 v80, v90, v130 op_sel:[0,0] op_sel_hi:[0,1]
    v_pk_mul_f16 v81, v90, v131 op_sel:[0,0] op_sel_hi:[0,1]
    v_pk_mul_f16 v82, v90, v132 op_sel:[0,0] op_sel_hi:[0,1]
    v_pk_mul_f16 v83, v90, v120 op_sel:[1,0] op_sel_hi:[1,1]
    v_mfma_f32_32x32x16_f16 v[32:47], v[148:151], v[84:87], v[32:47]
    v_pk_mul_f16 v84, v98, v144 op_sel:[0,0] op_sel_hi:[0,1]
    v_pk_mul_f16 v85, v98, v145 op_sel:[0,0] op_sel_hi:[0,1]
    v_pk_mul_f16 v86, v98, v146 op_sel:[0,0] op_sel_hi:[0,1]
    v_pk_mul_f16 v87, v98, v134 op_sel:[1,0] op_sel_hi:[1,1]
    s_waitcnt lgkmcnt(2)
    v_mfma_f32_32x32x16_f16 v[16:31], v[152:155], v[80:83], v[16:31]
    ds_read_b128 v[148:151], v3 offset:192
    v_pk_mul_f16 v80, v90, v121 op_sel:[1,0] op_sel_hi:[1,1]
    v_pk_mul_f16 v81, v90, v122 op_sel:[1,0] op_sel_hi:[1,1]
    v_pk_mul_f16 v82, v90, v123 op_sel:[1,0] op_sel_hi:[1,1]
    v_pk_mul_f16 v83, v90, v124 op_sel:[1,0] op_sel_hi:[1,1]
    v_mfma_f32_32x32x16_f16 v[32:47], v[152:155], v[84:87], v[32:47]
    v_pk_mul_f16 v84, v98, v135 op_sel:[1,0] op_sel_hi:[1,1]
    v_pk_mul_f16 v85, v98, v136 op_sel:[1,0] op_sel_hi:[1,1]
    v_pk_mul_f16 v86, v98, v137 op_sel:[1,0] op_sel_hi:[1,1]
    v_pk_mul_f16 v87, v98, v138 op_sel:[1,0] op_sel_hi:[1,1]
    s_waitcnt lgkmcnt(2)
    v_mfma_f32_32x32x16_f16 v[16:31], v[156:159], v[80:83], v[16:31]
    ds_read_b128 v[152:155], v3 offset:416
    v_pk_mul_f16 v80, v90, v125 op_sel:[1,0] op_sel_hi:[1,1]
    v_pk_mul_f16 v81, v90, v126 op_sel:[1,0] op_sel_hi:[1,1]
    v_pk_mul_f16 v82, v90, v127 op_sel:[1,0] op_sel_hi:[1,1]
    v_pk_mul_f16 v83, v90, v128 op_sel:[1,0] op_sel_hi:[1,1]
    v_mfma_f32_32x32x16_f16 v[32:47], v[156:159], v[84:87], v[32:47]
    v_pk_mul_f16 v84, v98, v139 op_sel:[1,0] op_sel_hi:[1,1]
    v_pk_mul_f16 v85, v98, v140 op_sel:[1,0] op_sel_hi:[1,1]
    v_pk_mul_f16 v86, v98, v141 op_sel:[1,0] op_sel_hi:[1,1]
    v_pk_mul_f16 v87, v98, v142 op_sel:[1,0] op_sel_hi:[1,1]
    s_waitcnt lgkmcnt(2)
    v_mfma_f32_32x32x16_f16 v[16:31], v[160:163], v[80:83], v[16:31]
    ds_read_b128 v[156:159], v3 offset:432
    v_pk_mul_f16 v80, v90, v129 op_sel:[1,0] op_sel_hi:[1,1]
    v_pk_mul_f16 v81, v90, v130 op_sel:[1,0] op_sel_hi:[1,1]
    v_pk_mul_f16 v82, v90, v131 op_sel:[1,0] op_sel_hi:[1,1]
    v_pk_mul_f16 v83, v90, v132 op_sel:[1,0] op_sel_hi:[1,1]
    v_mfma_f32_32x32x16_f16 v[32:47], v[160:163], v[84:87], v[32:47]
    v_pk_mul_f16 v84, v98, v143 op_sel:[1,0] op_sel_hi:[1,1]
    v_pk_mul_f16 v85, v98, v144 op_sel:[1,0] op_sel_hi:[1,1]
    v_pk_mul_f16 v86, v98, v145 op_sel:[1,0] op_sel_hi:[1,1]
    v_pk_mul_f16 v87, v98, v146 op_sel:[1,0] op_sel_hi:[1,1]
    s_waitcnt lgkmcnt(2)
    v_mfma_f32_32x32x16_f16 v[16:31], v[148:151], v[80:83], v[16:31]
    ds_read_b128 v[160:163], v3 offset:448
    v_pk_mul_f16 v80, v91, v120 op_sel:[0,0] op_sel_hi:[0,1]
    v_pk_mul_f16 v81, v91, v121 op_sel:[0,0] op_sel_hi:[0,1]
    v_pk_mul_f16 v82, v91, v122 op_sel:[0,0] op_sel_hi:[0,1]
    v_pk_mul_f16 v83, v91, v123 op_sel:[0,0] op_sel_hi:[0,1]
    v_mfma_f32_32x32x16_f16 v[32:47], v[148:151], v[84:87], v[32:47]
    v_pk_mul_f16 v84, v99, v134 op_sel:[0,0] op_sel_hi:[0,1]
    v_pk_mul_f16 v85, v99, v135 op_sel:[0,0] op_sel_hi:[0,1]
    v_pk_mul_f16 v86, v99, v136 op_sel:[0,0] op_sel_hi:[0,1]
    v_pk_mul_f16 v87, v99, v137 op_sel:[0,0] op_sel_hi:[0,1]
    s_waitcnt lgkmcnt(2)
    v_mfma_f32_32x32x16_f16 v[16:31], v[152:155], v[80:83], v[16:31]
    ds_read_b128 v[148:151], v3 offset:464
    v_pk_mul_f16 v80, v91, v124 op_sel:[0,0] op_sel_hi:[0,1]
    v_pk_mul_f16 v81, v91, v125 op_sel:[0,0] op_sel_hi:[0,1]
    v_pk_mul_f16 v82, v91, v126 op_sel:[0,0] op_sel_hi:[0,1]
    v_pk_mul_f16 v83, v91, v127 op_sel:[0,0] op_sel_hi:[0,1]
    v_mfma_f32_32x32x16_f16 v[32:47], v[152:155], v[84:87], v[32:47]
    v_pk_mul_f16 v84, v99, v138 op_sel:[0,0] op_sel_hi:[0,1]
    v_pk_mul_f16 v85, v99, v139 op_sel:[0,0] op_sel_hi:[0,1]
    v_pk_mul_f16 v86, v99, v140 op_sel:[0,0] op_sel_hi:[0,1]
    v_pk_mul_f16 v87, v99, v141 op_sel:[0,0] op_sel_hi:[0,1]
    s_waitcnt lgkmcnt(2)
    v_mfma_f32_32x32x16_f16 v[16:31], v[156:159], v[80:83], v[16:31]
    ds_read_b128 v[152:155], v3 offset:480
    v_pk_mul_f16 v80, v91, v128 op_sel:[0,0] op_sel_hi:[0,1]
    v_pk_mul_f16 v81, v91, v129 op_sel:[0,0] op_sel_hi:[0,1]
    v_pk_mul_f16 v82, v91, v130 op_sel:[0,0] op_sel_hi:[0,1]
    v_pk_mul_f16 v83, v91, v131 op_sel:[0,0] op_sel_hi:[0,1]
    v_mfma_f32_32x32x16_f16 v[32:47], v[156:159], v[84:87], v[32:47]
    v_pk_mul_f16 v84, v99, v142 op_sel:[0,0] op_sel_hi:[0,1]
    v_pk_mul_f16 v85, v99, v143 op_sel:[0,0] op_sel_hi:[0,1]
    v_pk_mul_f16 v86, v99, v144 op_sel:[0,0] op_sel_hi:[0,1]
    v_pk_mul_f16 v87, v99, v145 op_sel:[0,0] op_sel_hi:[0,1]
    s_waitcnt lgkmcnt(2)
    v_mfma_f32_32x32x16_f16 v[16:31], v[160:163], v[80:83], v[16:31]
    ds_read_b128 v[156:159], v3 offset:496
    v_pk_mul_f16 v80, v91, v132 op_sel:[0,0] op_sel_hi:[0,1]
    v_pk_mul_f16 v81, v91, v120 op_sel:[1,0] op_sel_hi:[1,1]
    v_pk_mul_f16 v82, v91, v121 op_sel:[1,0] op_sel_hi:[1,1]
    v_pk_mul_f16 v83, v91, v122 op_sel:[1,0] op_sel_hi:[1,1]
    v_mfma_f32_32x32x16_f16 v[32:47], v[160:163], v[84:87], v[32:47]
    v_pk_mul_f16 v84, v99, v146 op_sel:[0,0] op_sel_hi:[0,1]
    v_pk_mul_f16 v85, v99, v134 op_sel:[1,0] op_sel_hi:[1,1]
    v_pk_mul_f16 v86, v99, v135 op_sel:[1,0] op_sel_hi:[1,1]
    v_pk_mul_f16 v87, v99, v136 op_sel:[1,0] op_sel_hi:[1,1]
    s_waitcnt lgkmcnt(2)
    v_mfma_f32_32x32x16_f16 v[16:31], v[148:151], v[80:83], v[16:31]
    ds_read_b128 v[160:163], v3 offset:512
    v_pk_mul_f16 v80, v91, v123 op_sel:[1,0] op_sel_hi:[1,1]
    v_pk_mul_f16 v81, v91, v124 op_sel:[1,0] op_sel_hi:[1,1]
    v_pk_mul_f16 v82, v91, v125 op_sel:[1,0] op_sel_hi:[1,1]
    v_pk_mul_f16 v83, v91, v126 op_sel:[1,0] op_sel_hi:[1,1]
    v_mfma_f32_32x32x16_f16 v[32:47], v[148:151], v[84:87], v[32:47]
    v_pk_mul_f16 v84, v99, v137 op_sel:[1,0] op_sel_hi:[1,1]
    v_pk_mul_f16 v85, v99, v138 op_sel:[1,0] op_sel_hi:[1,1]
    v_pk_mul_f16 v86, v99, v139 op_sel:[1,0] op_sel_hi:[1,1]
    v_pk_mul_f16 v87, v99, v140 op_sel:[1,0] op_sel_hi:[1,1]
    s_waitcnt lgkmcnt(2)
    v_mfma_f32_32x32x16_f16 v[16:31], v[152:155], v[80:83], v[16:31]
    ds_read_b128 v[148:151], v3 offset:528
    v_pk_mul_f16 v80, v91, v127 op_sel:[1,0] op_sel_hi:[1,1]
    v_pk_mul_f16 v81, v91, v128 op_sel:[1,0] op_sel_hi:[1,1]
    v_pk_mul_f16 v82, v91, v129 op_sel:[1,0] op_sel_hi:[1,1]
    v_pk_mul_f16 v83, v91, v130 op_sel:[1,0] op_sel_hi:[1,1]
    v_mfma_f32_32x32x16_f16 v[32:47], v[152:155], v[84:87], v[32:47]
    v_pk_mul_f16 v84, v99, v141 op_sel:[1,0] op_sel_hi:[1,1]
    v_pk_mul_f16 v85, v99, v142 op_sel:[1,0] op_sel_hi:[1,1]
    v_pk_mul_f16 v86, v99, v143 op_sel:[1,0] op_sel_hi:[1,1]
    v_pk_mul_f16 v87, v99, v144 op_sel:[1,0] op_sel_hi:[1,1]
    s_waitcnt lgkmcnt(2)
    v_mfma_f32_32x32x16_f16 v[16:31], v[156:159], v[80:83], v[16:31]
    ds_read_b128 v[152:155], v3 offset:544
    v_pk_mul_f16 v80, v91, v131 op_sel:[1,0] op_sel_hi:[1,1]
    v_pk_mul_f16 v81, v91, v132 op_sel:[1,0] op_sel_hi:[1,1]
    v_pk_mul_f16 v82, v92, v120 op_sel:[0,0] op_sel_hi:[0,1]
    v_pk_mul_f16 v83, v92, v121 op_sel:[0,0] op_sel_hi:[0,1]
    v_mfma_f32_32x32x16_f16 v[32:47], v[156:159], v[84:87], v[32:47]
    v_pk_mul_f16 v84, v99, v145 op_sel:[1,0] op_sel_hi:[1,1]
    v_pk_mul_f16 v85, v99, v146 op_sel:[1,0] op_sel_hi:[1,1]
    v_pk_mul_f16 v86, v100, v134 op_sel:[0,0] op_sel_hi:[0,1]
    v_pk_mul_f16 v87, v100, v135 op_sel:[0,0] op_sel_hi:[0,1]
    s_waitcnt lgkmcnt(2)
    v_mfma_f32_32x32x16_f16 v[16:31], v[160:163], v[80:83], v[16:31]
    ds_read_b128 v[156:159], v3 offset:560
    v_pk_mul_f16 v80, v92, v122 op_sel:[0,0] op_sel_hi:[0,1]
    v_pk_mul_f16 v81, v92, v123 op_sel:[0,0] op_sel_hi:[0,1]
    v_pk_mul_f16 v82, v92, v124 op_sel:[0,0] op_sel_hi:[0,1]
    v_pk_mul_f16 v83, v92, v125 op_sel:[0,0] op_sel_hi:[0,1]
    v_mfma_f32_32x32x16_f16 v[32:47], v[160:163], v[84:87], v[32:47]
    v_pk_mul_f16 v84, v100, v136 op_sel:[0,0] op_sel_hi:[0,1]
    v_pk_mul_f16 v85, v100, v137 op_sel:[0,0] op_sel_hi:[0,1]
    v_pk_mul_f16 v86, v100, v138 op_sel:[0,0] op_sel_hi:[0,1]
    v_pk_mul_f16 v87, v100, v139 op_sel:[0,0] op_sel_hi:[0,1]
    s_waitcnt lgkmcnt(2)
    v_mfma_f32_32x32x16_f16 v[16:31], v[148:151], v[80:83], v[16:31]
    ds_read_b128 v[160:163], v3 offset:576
    v_pk_mul_f16 v80, v92, v126 op_sel:[0,0] op_sel_hi:[0,1]
    v_pk_mul_f16 v81, v92, v127 op_sel:[0,0] op_sel_hi:[0,1]
    v_pk_mul_f16 v82, v92, v128 op_sel:[0,0] op_sel_hi:[0,1]
    v_pk_mul_f16 v83, v92, v129 op_sel:[0,0] op_sel_hi:[0,1]
    v_mfma_f32_32x32x16_f16 v[32:47], v[148:151], v[84:87], v[32:47]
    v_pk_mul_f16 v84, v100, v140 op_sel:[0,0] op_sel_hi:[0,1]
    v_pk_mul_f16 v85, v100, v141 op_sel:[0,0] op_sel_hi:[0,1]
    v_pk_mul_f16 v86, v100, v142 op_sel:[0,0] op_sel_hi:[0,1]
    v_pk_mul_f16 v87, v100, v143 op_sel:[0,0] op_sel_hi:[0,1]
    s_waitcnt lgkmcnt(2)
    v_mfma_f32_32x32x16_f16 v[16:31], v[152:155], v[80:83], v[16:31]
    ds_read_b128 v[148:151], v3 offset:592
    v_pk_mul_f16 v80, v92, v130 op_sel:[0,0] op_sel_hi:[0,1]
    v_pk_mul_f16 v81, v92, v131 op_sel:[0,0] op_sel_hi:[0,1]
    v_pk_mul_f16 v82, v92, v132 op_sel:[0,0] op_sel_hi:[0,1]
    v_pk_mul_f16 v83, v92, v120 op_sel:[1,0] op_sel_hi:[1,1]
    v_mfma_f32_32x32x16_f16 v[32:47], v[152:155], v[84:87], v[32:47]
    v_pk_mul_f16 v84, v100, v144 op_sel:[0,0] op_sel_hi:[0,1]
    v_pk_mul_f16 v85, v100, v145 op_sel:[0,0] op_sel_hi:[0,1]
    v_pk_mul_f16 v86, v100, v146 op_sel:[0,0] op_sel_hi:[0,1]
    v_pk_mul_f16 v87, v100, v134 op_sel:[1,0] op_sel_hi:[1,1]
    s_waitcnt lgkmcnt(2)
    v_mfma_f32_32x32x16_f16 v[16:31], v[156:159], v[80:83], v[16:31]
    ds_read_b128 v[152:155], v3 offset:608
    v_pk_mul_f16 v80, v92, v121 op_sel:[1,0] op_sel_hi:[1,1]
    v_pk_mul_f16 v81, v92, v122 op_sel:[1,0] op_sel_hi:[1,1]
    v_pk_mul_f16 v82, v92, v123 op_sel:[1,0] op_sel_hi:[1,1]
    v_pk_mul_f16 v83, v92, v124 op_sel:[1,0] op_sel_hi:[1,1]
    v_mfma_f32_32x32x16_f16 v[32:47], v[156:159], v[84:87], v[32:47]
    v_pk_mul_f16 v84, v100, v135 op_sel:[1,0] op_sel_hi:[1,1]
    v_pk_mul_f16 v85, v100, v136 op_sel:[1,0] op_sel_hi:[1,1]
    v_pk_mul_f16 v86, v100, v137 op_sel:[1,0] op_sel_hi:[1,1]
    v_pk_mul_f16 v87, v100, v138 op_sel:[1,0] op_sel_hi:[1,1]
    s_waitcnt lgkmcnt(2)
    v_mfma_f32_32x32x16_f16 v[16:31], v[160:163], v[80:83], v[16:31]
    ds_read_b128 v[156:159], v3 offset:832
    v_pk_mul_f16 v80, v92, v125 op_sel:[1,0] op_sel_hi:[1,1]
    v_pk_mul_f16 v81, v92, v126 op_sel:[1,0] op_sel_hi:[1,1]
    v_pk_mul_f16 v82, v92, v127 op_sel:[1,0] op_sel_hi:[1,1]
    v_pk_mul_f16 v83, v92, v128 op_sel:[1,0] op_sel_hi:[1,1]
    v_mfma_f32_32x32x16_f16 v[32:47], v[160:163], v[84:87], v[32:47]
    v_pk_mul_f16 v84, v100, v139 op_sel:[1,0] op_sel_hi:[1,1]
    v_pk_mul_f16 v85, v100, v140 op_sel:[1,0] op_sel_hi:[1,1]
    v_pk_mul_f16 v86, v100, v141 op_sel:[1,0] op_sel_hi:[1,1]
    v_pk_mul_f16 v87, v100, v142 op_sel:[1,0] op_sel_hi:[1,1]
    s_waitcnt lgkmcnt(2)
    v_mfma_f32_32x32x16_f16 v[16:31], v[148:151], v[80:83], v[16:31]
    ds_read_b128 v[160:163], v3 offset:848
    v_pk_mul_f16 v80, v92, v129 op_sel:[1,0] op_sel_hi:[1,1]
    v_pk_mul_f16 v81, v92, v130 op_sel:[1,0] op_sel_hi:[1,1]
    v_pk_mul_f16 v82, v92, v131 op_sel:[1,0] op_sel_hi:[1,1]
    v_pk_mul_f16 v83, v92, v132 op_sel:[1,0] op_sel_hi:[1,1]
    v_mfma_f32_32x32x16_f16 v[32:47], v[148:151], v[84:87], v[32:47]
    v_pk_mul_f16 v84, v100, v143 op_sel:[1,0] op_sel_hi:[1,1]
    v_pk_mul_f16 v85, v100, v144 op_sel:[1,0] op_sel_hi:[1,1]
    v_pk_mul_f16 v86, v100, v145 op_sel:[1,0] op_sel_hi:[1,1]
    v_pk_mul_f16 v87, v100, v146 op_sel:[1,0] op_sel_hi:[1,1]
    s_waitcnt lgkmcnt(2)
    v_mfma_f32_32x32x16_f16 v[16:31], v[152:155], v[80:83], v[16:31]
    ds_read_b128 v[148:151], v3 offset:864
    v_pk_mul_f16 v80, v93, v120 op_sel:[0,0] op_sel_hi:[0,1]
    v_pk_mul_f16 v81, v93, v121 op_sel:[0,0] op_sel_hi:[0,1]
    v_pk_mul_f16 v82, v93, v122 op_sel:[0,0] op_sel_hi:[0,1]
    v_pk_mul_f16 v83, v93, v123 op_sel:[0,0] op_sel_hi:[0,1]
    v_mfma_f32_32x32x16_f16 v[32:47], v[152:155], v[84:87], v[32:47]
    v_pk_mul_f16 v84, v101, v134 op_sel:[0,0] op_sel_hi:[0,1]
    v_pk_mul_f16 v85, v101, v135 op_sel:[0,0] op_sel_hi:[0,1]
    v_pk_mul_f16 v86, v101, v136 op_sel:[0,0] op_sel_hi:[0,1]
    v_pk_mul_f16 v87, v101, v137 op_sel:[0,0] op_sel_hi:[0,1]
    s_waitcnt lgkmcnt(2)
    v_mfma_f32_32x32x16_f16 v[16:31], v[156:159], v[80:83], v[16:31]
    ds_read_b128 v[152:155], v3 offset:880
    v_pk_mul_f16 v80, v93, v124 op_sel:[0,0] op_sel_hi:[0,1]
    v_pk_mul_f16 v81, v93, v125 op_sel:[0,0] op_sel_hi:[0,1]
    v_pk_mul_f16 v82, v93, v126 op_sel:[0,0] op_sel_hi:[0,1]
    v_pk_mul_f16 v83, v93, v127 op_sel:[0,0] op_sel_hi:[0,1]
    v_mfma_f32_32x32x16_f16 v[32:47], v[156:159], v[84:87], v[32:47]
    v_pk_mul_f16 v84, v101, v138 op_sel:[0,0] op_sel_hi:[0,1]
    v_pk_mul_f16 v85, v101, v139 op_sel:[0,0] op_sel_hi:[0,1]
    v_pk_mul_f16 v86, v101, v140 op_sel:[0,0] op_sel_hi:[0,1]
    v_pk_mul_f16 v87, v101, v141 op_sel:[0,0] op_sel_hi:[0,1]
    s_waitcnt lgkmcnt(2)
    v_mfma_f32_32x32x16_f16 v[16:31], v[160:163], v[80:83], v[16:31]
    ds_read_b128 v[156:159], v3 offset:896
    v_pk_mul_f16 v80, v93, v128 op_sel:[0,0] op_sel_hi:[0,1]
    v_pk_mul_f16 v81, v93, v129 op_sel:[0,0] op_sel_hi:[0,1]
    v_pk_mul_f16 v82, v93, v130 op_sel:[0,0] op_sel_hi:[0,1]
    v_pk_mul_f16 v83, v93, v131 op_sel:[0,0] op_sel_hi:[0,1]
    v_mfma_f32_32x32x16_f16 v[32:47], v[160:163], v[84:87], v[32:47]
    v_pk_mul_f16 v84, v101, v142 op_sel:[0,0] op_sel_hi:[0,1]
    v_pk_mul_f16 v85, v101, v143 op_sel:[0,0] op_sel_hi:[0,1]
    v_pk_mul_f16 v86, v101, v144 op_sel:[0,0] op_sel_hi:[0,1]
    v_pk_mul_f16 v87, v101, v145 op_sel:[0,0] op_sel_hi:[0,1]
    s_waitcnt lgkmcnt(2)
    v_mfma_f32_32x32x16_f16 v[16:31], v[148:151], v[80:83], v[16:31]
    ds_read_b128 v[160:163], v3 offset:912
    v_pk_mul_f16 v80, v93, v132 op_sel:[0,0] op_sel_hi:[0,1]
    v_pk_mul_f16 v81, v93, v120 op_sel:[1,0] op_sel_hi:[1,1]
    v_pk_mul_f16 v82, v93, v121 op_sel:[1,0] op_sel_hi:[1,1]
    v_pk_mul_f16 v83, v93, v122 op_sel:[1,0] op_sel_hi:[1,1]
    v_mfma_f32_32x32x16_f16 v[32:47], v[148:151], v[84:87], v[32:47]
    v_pk_mul_f16 v84, v101, v146 op_sel:[0,0] op_sel_hi:[0,1]
    v_pk_mul_f16 v85, v101, v134 op_sel:[1,0] op_sel_hi:[1,1]
    v_pk_mul_f16 v86, v101, v135 op_sel:[1,0] op_sel_hi:[1,1]
    v_pk_mul_f16 v87, v101, v136 op_sel:[1,0] op_sel_hi:[1,1]
    s_waitcnt lgkmcnt(2)
    v_mfma_f32_32x32x16_f16 v[16:31], v[152:155], v[80:83], v[16:31]
    ds_read_b128 v[148:151], v3 offset:928
    v_pk_mul_f16 v80, v93, v123 op_sel:[1,0] op_sel_hi:[1,1]
    v_pk_mul_f16 v81, v93, v124 op_sel:[1,0] op_sel_hi:[1,1]
    v_pk_mul_f16 v82, v93, v125 op_sel:[1,0] op_sel_hi:[1,1]
    v_pk_mul_f16 v83, v93, v126 op_sel:[1,0] op_sel_hi:[1,1]
    v_mfma_f32_32x32x16_f16 v[32:47], v[152:155], v[84:87], v[32:47]
    v_pk_mul_f16 v84, v101, v137 op_sel:[1,0] op_sel_hi:[1,1]
    v_pk_mul_f16 v85, v101, v138 op_sel:[1,0] op_sel_hi:[1,1]
    v_pk_mul_f16 v86, v101, v139 op_sel:[1,0] op_sel_hi:[1,1]
    v_pk_mul_f16 v87, v101, v140 op_sel:[1,0] op_sel_hi:[1,1]
    s_waitcnt lgkmcnt(2)
    v_mfma_f32_32x32x16_f16 v[16:31], v[156:159], v[80:83], v[16:31]
    ds_read_b128 v[152:155], v3 offset:944
    v_pk_mul_f16 v80, v93, v127 op_sel:[1,0] op_sel_hi:[1,1]
    v_pk_mul_f16 v81, v93, v128 op_sel:[1,0] op_sel_hi:[1,1]
    v_pk_mul_f16 v82, v93, v129 op_sel:[1,0] op_sel_hi:[1,1]
    v_pk_mul_f16 v83, v93, v130 op_sel:[1,0] op_sel_hi:[1,1]
    v_mfma_f32_32x32x16_f16 v[32:47], v[156:159], v[84:87], v[32:47]
    v_pk_mul_f16 v84, v101, v141 op_sel:[1,0] op_sel_hi:[1,1]
    v_pk_mul_f16 v85, v101, v142 op_sel:[1,0] op_sel_hi:[1,1]
    v_pk_mul_f16 v86, v101, v143 op_sel:[1,0] op_sel_hi:[1,1]
    v_pk_mul_f16 v87, v101, v144 op_sel:[1,0] op_sel_hi:[1,1]
    s_waitcnt lgkmcnt(2)
    v_mfma_f32_32x32x16_f16 v[16:31], v[160:163], v[80:83], v[16:31]
    ds_read_b128 v[156:159], v3 offset:960
    v_pk_mul_f16 v80, v93, v131 op_sel:[1,0] op_sel_hi:[1,1]
    v_pk_mul_f16 v81, v93, v132 op_sel:[1,0] op_sel_hi:[1,1]
    v_pk_mul_f16 v82, v94, v120 op_sel:[0,0] op_sel_hi:[0,1]
    v_pk_mul_f16 v83, v94, v121 op_sel:[0,0] op_sel_hi:[0,1]
    v_mfma_f32_32x32x16_f16 v[32:47], v[160:163], v[84:87], v[32:47]
    v_pk_mul_f16 v84, v101, v145 op_sel:[1,0] op_sel_hi:[1,1]
    v_pk_mul_f16 v85, v101, v146 op_sel:[1,0] op_sel_hi:[1,1]
    v_pk_mul_f16 v86, v102, v134 op_sel:[0,0] op_sel_hi:[0,1]
    v_pk_mul_f16 v87, v102, v135 op_sel:[0,0] op_sel_hi:[0,1]
    s_waitcnt lgkmcnt(2)
    v_mfma_f32_32x32x16_f16 v[16:31], v[148:151], v[80:83], v[16:31]
    ds_read_b128 v[160:163], v3 offset:976
    v_pk_mul_f16 v80, v94, v122 op_sel:[0,0] op_sel_hi:[0,1]
    v_pk_mul_f16 v81, v94, v123 op_sel:[0,0] op_sel_hi:[0,1]
    v_pk_mul_f16 v82, v94, v124 op_sel:[0,0] op_sel_hi:[0,1]
    v_pk_mul_f16 v83, v94, v125 op_sel:[0,0] op_sel_hi:[0,1]
    v_mfma_f32_32x32x16_f16 v[32:47], v[148:151], v[84:87], v[32:47]
    v_pk_mul_f16 v84, v102, v136 op_sel:[0,0] op_sel_hi:[0,1]
    v_pk_mul_f16 v85, v102, v137 op_sel:[0,0] op_sel_hi:[0,1]
    v_pk_mul_f16 v86, v102, v138 op_sel:[0,0] op_sel_hi:[0,1]
    v_pk_mul_f16 v87, v102, v139 op_sel:[0,0] op_sel_hi:[0,1]
    s_waitcnt lgkmcnt(2)
    v_mfma_f32_32x32x16_f16 v[16:31], v[152:155], v[80:83], v[16:31]
    ds_read_b128 v[148:151], v3 offset:992
    v_pk_mul_f16 v80, v94, v126 op_sel:[0,0] op_sel_hi:[0,1]
    v_pk_mul_f16 v81, v94, v127 op_sel:[0,0] op_sel_hi:[0,1]
    v_pk_mul_f16 v82, v94, v128 op_sel:[0,0] op_sel_hi:[0,1]
    v_pk_mul_f16 v83, v94, v129 op_sel:[0,0] op_sel_hi:[0,1]
    v_mfma_f32_32x32x16_f16 v[32:47], v[152:155], v[84:87], v[32:47]
    v_pk_mul_f16 v84, v102, v140 op_sel:[0,0] op_sel_hi:[0,1]
    v_pk_mul_f16 v85, v102, v141 op_sel:[0,0] op_sel_hi:[0,1]
    v_pk_mul_f16 v86, v102, v142 op_sel:[0,0] op_sel_hi:[0,1]
    v_pk_mul_f16 v87, v102, v143 op_sel:[0,0] op_sel_hi:[0,1]
    s_waitcnt lgkmcnt(2)
    v_mfma_f32_32x32x16_f16 v[16:31], v[156:159], v[80:83], v[16:31]
    ds_read_b128 v[152:155], v3 offset:1008
    v_pk_mul_f16 v80, v94, v130 op_sel:[0,0] op_sel_hi:[0,1]
    v_pk_mul_f16 v81, v94, v131 op_sel:[0,0] op_sel_hi:[0,1]
    v_pk_mul_f16 v82, v94, v132 op_sel:[0,0] op_sel_hi:[0,1]
    v_pk_mul_f16 v83, v94, v120 op_sel:[1,0] op_sel_hi:[1,1]
    v_mfma_f32_32x32x16_f16 v[32:47], v[156:159], v[84:87], v[32:47]
    v_pk_mul_f16 v84, v102, v144 op_sel:[0,0] op_sel_hi:[0,1]
    v_pk_mul_f16 v85, v102, v145 op_sel:[0,0] op_sel_hi:[0,1]
    v_pk_mul_f16 v86, v102, v146 op_sel:[0,0] op_sel_hi:[0,1]
    v_pk_mul_f16 v87, v102, v134 op_sel:[1,0] op_sel_hi:[1,1]
    s_waitcnt lgkmcnt(2)
    v_mfma_f32_32x32x16_f16 v[16:31], v[160:163], v[80:83], v[16:31]
    ds_read_b128 v[156:159], v3 offset:1024
    v_pk_mul_f16 v80, v94, v121 op_sel:[1,0] op_sel_hi:[1,1]
    v_pk_mul_f16 v81, v94, v122 op_sel:[1,0] op_sel_hi:[1,1]
    v_pk_mul_f16 v82, v94, v123 op_sel:[1,0] op_sel_hi:[1,1]
    v_pk_mul_f16 v83, v94, v124 op_sel:[1,0] op_sel_hi:[1,1]
    v_mfma_f32_32x32x16_f16 v[32:47], v[160:163], v[84:87], v[32:47]
    v_pk_mul_f16 v84, v102, v135 op_sel:[1,0] op_sel_hi:[1,1]
    v_pk_mul_f16 v85, v102, v136 op_sel:[1,0] op_sel_hi:[1,1]
    v_pk_mul_f16 v86, v102, v137 op_sel:[1,0] op_sel_hi:[1,1]
    v_pk_mul_f16 v87, v102, v138 op_sel:[1,0] op_sel_hi:[1,1]
    s_waitcnt lgkmcnt(2)
    v_mfma_f32_32x32x16_f16 v[16:31], v[148:151], v[80:83], v[16:31]
    ds_read_b128 v[160:163], v4 offset:0
    v_pk_mul_f16 v80, v94, v125 op_sel:[1,0] op_sel_hi:[1,1]
    v_pk_mul_f16 v81, v94, v126 op_sel:[1,0] op_sel_hi:[1,1]
    v_pk_mul_f16 v82, v94, v127 op_sel:[1,0] op_sel_hi:[1,1]
    v_pk_mul_f16 v83, v94, v128 op_sel:[1,0] op_sel_hi:[1,1]
    v_mfma_f32_32x32x16_f16 v[32:47], v[148:151], v[84:87], v[32:47]
    v_pk_mul_f16 v84, v102, v139 op_sel:[1,0] op_sel_hi:[1,1]
    v_pk_mul_f16 v85, v102, v140 op_sel:[1,0] op_sel_hi:[1,1]
    v_pk_mul_f16 v86, v102, v141 op_sel:[1,0] op_sel_hi:[1,1]
    v_pk_mul_f16 v87, v102, v142 op_sel:[1,0] op_sel_hi:[1,1]
    s_waitcnt lgkmcnt(2)
    v_mfma_f32_32x32x16_f16 v[16:31], v[152:155], v[80:83], v[16:31]
    ds_read_b128 v[148:151], v4 offset:16
    v_pk_mul_f16 v80, v94, v129 op_sel:[1,0] op_sel_hi:[1,1]
    v_pk_mul_f16 v81, v94, v130 op_sel:[1,0] op_sel_hi:[1,1]
    v_pk_mul_f16 v82, v94, v131 op_sel:[1,0] op_sel_hi:[1,1]
    v_pk_mul_f16 v83, v94, v132 op_sel:[1,0] op_sel_hi:[1,1]
    v_mfma_f32_32x32x16_f16 v[32:47], v[152:155], v[84:87], v[32:47]
    v_pk_mul_f16 v84, v102, v143 op_sel:[1,0] op_sel_hi:[1,1]
    v_pk_mul_f16 v85, v102, v144 op_sel:[1,0] op_sel_hi:[1,1]
    v_pk_mul_f16 v86, v102, v145 op_sel:[1,0] op_sel_hi:[1,1]
    v_pk_mul_f16 v87, v102, v146 op_sel:[1,0] op_sel_hi:[1,1]
    s_waitcnt lgkmcnt(2)
    v_mfma_f32_32x32x16_f16 v[16:31], v[156:159], v[80:83], v[16:31]
    ds_read_b128 v[152:155], v4 offset:32
    ds_read_b32 v167, v165 offset:12
    v_pk_mul_f16 v80, v95, v120 op_sel:[0,0] op_sel_hi:[0,1]
    v_pk_mul_f16 v81, v95, v121 op_sel:[0,0] op_sel_hi:[0,1]
    v_pk_mul_f16 v82, v95, v122 op_sel:[0,0] op_sel_hi:[0,1]
    v_pk_mul_f16 v83, v95, v123 op_sel:[0,0] op_sel_hi:[0,1]
    v_mfma_f32_32x32x16_f16 v[32:47], v[156:159], v[84:87], v[32:47]
    v_pk_mul_f16 v84, v103, v134 op_sel:[0,0] op_sel_hi:[0,1]
    v_pk_mul_f16 v85, v103, v135 op_sel:[0,0] op_sel_hi:[0,1]
    v_pk_mul_f16 v86, v103, v136 op_sel:[0,0] op_sel_hi:[0,1]
    v_pk_mul_f16 v87, v103, v137 op_sel:[0,0] op_sel_hi:[0,1]
    s_waitcnt lgkmcnt(3)
    v_mfma_f32_32x32x16_f16 v[16:31], v[160:163], v[80:83], v[16:31]
    ds_read_b128 v[156:159], v4 offset:48
    v_pk_mul_f16 v80, v95, v124 op_sel:[0,0] op_sel_hi:[0,1]
    v_pk_mul_f16 v81, v95, v125 op_sel:[0,0] op_sel_hi:[0,1]
    v_pk_mul_f16 v82, v95, v126 op_sel:[0,0] op_sel_hi:[0,1]
    v_pk_mul_f16 v83, v95, v127 op_sel:[0,0] op_sel_hi:[0,1]
    v_mfma_f32_32x32x16_f16 v[32:47], v[160:163], v[84:87], v[32:47]
    v_pk_mul_f16 v84, v103, v138 op_sel:[0,0] op_sel_hi:[0,1]
    v_pk_mul_f16 v85, v103, v139 op_sel:[0,0] op_sel_hi:[0,1]
    v_pk_mul_f16 v86, v103, v140 op_sel:[0,0] op_sel_hi:[0,1]
    v_pk_mul_f16 v87, v103, v141 op_sel:[0,0] op_sel_hi:[0,1]
    s_waitcnt lgkmcnt(3)
    v_mfma_f32_32x32x16_f16 v[16:31], v[148:151], v[80:83], v[16:31]
    ds_read_b128 v[160:163], v4 offset:64
    v_pk_mul_f16 v80, v95, v128 op_sel:[0,0] op_sel_hi:[0,1]
    v_pk_mul_f16 v81, v95, v129 op_sel:[0,0] op_sel_hi:[0,1]
    v_pk_mul_f16 v82, v95, v130 op_sel:[0,0] op_sel_hi:[0,1]
    v_pk_mul_f16 v83, v95, v131 op_sel:[0,0] op_sel_hi:[0,1]
    v_mfma_f32_32x32x16_f16 v[32:47], v[148:151], v[84:87], v[32:47]
    v_pk_mul_f16 v84, v103, v142 op_sel:[0,0] op_sel_hi:[0,1]
    v_pk_mul_f16 v85, v103, v143 op_sel:[0,0] op_sel_hi:[0,1]
    v_pk_mul_f16 v86, v103, v144 op_sel:[0,0] op_sel_hi:[0,1]
    v_pk_mul_f16 v87, v103, v145 op_sel:[0,0] op_sel_hi:[0,1]
    s_waitcnt lgkmcnt(3)
    v_mfma_f32_32x32x16_f16 v[16:31], v[152:155], v[80:83], v[16:31]
    s_waitcnt lgkmcnt(2)
    v_readfirstlane_b32 s40, v167
    s_cmp_ge_u32 s40, s47
    s_cbranch_scc1 L_wfok11
    s_branch L_wf13
L_wf12:
    s_sleep 1
L_wf13:
    ds_read_b32 v167, v165 offset:12
    s_waitcnt lgkmcnt(0)
    v_readfirstlane_b32 s40, v167
    s_cmp_lt_u32 s40, s47
    s_cbranch_scc1 L_wf12
L_wfok11:
    ds_read_b128 v[148:151], v12 offset:0
    v_pk_mul_f16 v88, v95, v132 op_sel:[0,0] op_sel_hi:[0,1]
    v_mfma_f32_32x32x16_f16 v[32:47], v[152:155], v[84:87], v[32:47]
    v_pk_mul_f16 v96, v103, v146 op_sel:[0,0] op_sel_hi:[0,1]
    s_waitcnt lgkmcnt(2)
    v_mfma_f32_32x32x16_f16 v[16:31], v[156:159], v[88:91], v[16:31]
    ds_read_b128 v[152:155], v12 offset:16
    v_mfma_f32_32x32x16_f16 v[32:47], v[156:159], v[96:99], v[32:47]
    s_waitcnt lgkmcnt(2)
    v_mfma_f32_32x32x16_f16 v[16:31], v[160:163], v[92:95], v[16:31]
    ds_read_b128 v[156:159], v12 offset:32
    s_mov_b64 exec, 1
    ds_add_u32 v165, v166 offset:16
    s_mov_b64 exec, -1
    v_mfma_f32_32x32x16_f16 v[32:47], v[160:163], v[100:103], v[32:47]
    s_cmp_eq_u32 s42, 2
    s_cbranch_scc1 L_last
    v_add_u32 v3, s43, v3
    v_add_u32 v4, s43, v4
    s_sub_u32 s43, 0, s43
    s_add_u32 s42, s42, 1
    s_add_u32 s47, s47, 4
    v_add_u32 v12, s43, v3
    s_cmp_eq_u32 s42, 2
    s_cbranch_scc0 L_nx_ok
    v_mov_b32 v12, v2
L_nx_ok:
    s_nop 1
    v_cvt_pk_f16_f32 v89, v16, v17
    v_cvt_pk_f16_f32 v90, v18, v19
    v_cvt_pk_f16_f32 v91, v20, v21
    v_cvt_pk_f16_f32 v92, v22, v23
    v_cvt_pk_f16_f32 v93, v24, v25
    v_cvt_pk_f16_f32 v94, v26, v27
    v_cvt_pk_f16_f32 v95, v28, 0
    v_pk_mul_f16 v80, v89, v120 op_sel:[0,0] op_sel_hi:[0,1]
    v_pk_mul_f16 v81, v89, v121 op_sel:[0,0] op_sel_hi:[0,1]
    v_pk_mul_f16 v82, v89, v122 op_sel:[0,0] op_sel_hi:[0,1]
    v_pk_mul_f16 v83, v89, v123 op_sel:[0,0] op_sel_hi:[0,1]
    v_add_f32 v5, v5, v29
    v_max3_f32 v8, abs(v16), abs(v17), abs(v18)
    v_max3_f32 v8, abs(v19), abs(v20), v8
    v_min_f32 v7, v7, v8
    v_cvt_pk_f16_f32 v97, v32, v33
    v_cvt_pk_f16_f32 v98, v34, v35
    v_cvt_pk_f16_f32 v99, v36, v37
    v_cvt_pk_f16_f32 v100, v38, v39
    v_cvt_pk_f16_f32 v101, v40, v41
    v_cvt_pk_f16_f32 v102, v42, v43
    v_cvt_pk_f16_f32 v103, v44, 0
    v_pk_mul_f16 v84, v97, v134 op_sel:[0,0] op_sel_hi:[0,1]
    v_pk_mul_f16 v85, v97, v135 op_sel:[0,0] op_sel_hi:[0,1]
    v_pk_mul_f16 v86, v97, v136 op_sel:[0,0] op_sel_hi:[0,1]
    v_pk_mul_f16 v87, v97, v137 op_sel:[0,0] op_sel_hi:[0,1]
    v_add_f32 v6, v6, v45
    v_max3_f32 v8, abs(v32), abs(v33), abs(v34)
    v_max3_f32 v8, abs(v35), abs(v36), v8
    v_min_f32 v7, v7, v8
    s_waitcnt lgkmcnt(0)
    s_branch L_layer
L_last:
    v_pk_mul_f16 v80, v104, v120 op_sel:[0,0] op_sel_hi:[0,1]
    v_pk_mul_f16 v81, v104, v121 op_sel:[0,0] op_sel_hi:[0,1]
    v_pk_mul_f16 v82, v104, v122 op_sel:[0,0] op_sel_hi:[0,1]
    v_pk_mul_f16 v83, v104, v123 op_sel:[0,0] op_sel_hi:[0,1]
    v_pk_mul_f16 v84, v112, v134 op_sel:[0,0] op_sel_hi:[0,1]
    v_pk_mul_f16 v85, v112, v135 op_sel:[0,0] op_sel_hi:[0,1]
    v_pk_mul_f16 v86, v112, v136 op_sel:[0,0] op_sel_hi:[0,1]
    v_pk_mul_f16 v87, v112, v137 op_sel:[0,0] op_sel_hi:[0,1]
    s_waitcnt lgkmcnt(3)
    v_mfma_f32_32x32x16_f16 v[48:63], v[148:151], v[80:83], 0
    ds_read_b128 v[160:163], v2 offset:48
    v_pk_mul_f16 v80, v104, v124 op_sel:[0,0] op_sel_hi:[0,1]
    v_pk_mul_f16 v81, v104, v125 op_sel:[0,0] op_sel_hi:[0,1]
    v_pk_mul_f16 v82, v104, v126 op_sel:[0,0] op_sel_hi:[0,1]
    v_pk_mul_f16 v83, v104, v127 op_sel:[0,0] op_sel_hi:[0,1]
    v_mfma_f32_32x32x16_f16 v[64:79], v[148:151], v[84:87], 0
    v_pk_mul_f16 v84, v112, v138 op_sel:[0,0] op_sel_hi:[0,1]
    v_pk_mul_f16 v85, v112, v139 op_sel:[0,0] op_sel_hi:[0,1]
    v_pk_mul_f16 v86, v112, v140 op_sel:[0,0] op_sel_hi:[0,1]
    v_pk_mul_f16 v87, v112, v141 op_sel:[0,0] op_sel_hi:[0,1]
    s_waitcnt lgkmcnt(3)
    v_mfma_f32_32x32x16_f16 v[48:63], v[152:155], v[80:83], v[48:63]
    ds_read_b128 v[148:151], v2 offset:64
    v_pk_mul_f16 v80, v104, v128 op_sel:[0,0] op_sel_hi:[0,1]
    v_pk_mul_f16 v81, v104, v129 op_sel:[0,0] op_sel_hi:[0,1]
    v_pk_mul_f16 v82, v104, v130 op_sel:[0,0] op_sel_hi:[0,1]
    v_pk_mul_f16 v83, v104, v131 op_sel:[0,0] op_sel_hi:[0,1]
    v_mfma_f32_32x32x16_f16 v[64:79], v[152:155], v[84:87], v[64:79]
    v_pk_mul_f16 v84, v112, v142 op_sel:[0,0] op_sel_hi:[0,1]
    v_pk_mul_f16 v85, v112, v143 op_sel:[0,0] op_sel_hi:[0,1]
    v_pk_mul_f16 v86, v112, v144 op_sel:[0,0] op_sel_hi:[0,1]
    v_pk_mul_f16 v87, v112, v145 op_sel:[0,0] op_sel_hi:[0,1]
    s_waitcnt lgkmcnt(3)
    v_mfma_f32_32x32x16_f16 v[48:63], v[156:159], v[80:83], v[48:63]
    ds_read_b128 v[152:155], v2 offset:80
    v_pk_mul_f16 v80, v104, v132 op_sel:[0,0] op_sel_hi:[0,1]
    v_pk_mul_f16 v81, v104, v121 op_sel:[1,0] op_sel_hi:[1,1]
    v_pk_mul_f16 v82, v104, v122 op_sel:[1,0] op_sel_hi:[1,1]
    v_pk_mul_f16 v83, v104, v123 op_sel:[1,0] op_sel_hi:[1,1]
    v_mfma_f32_32x32x16_f16 v[64:79], v[156:159], v[84:87], v[64:79]
    v_pk_mul_f16 v84, v112, v146 op_sel:[0,0] op_sel_hi:[0,1]
    v_pk_mul_f16 v85, v112, v135 op_sel:[1,0] op_sel_hi:[1,1]
    v_pk_mul_f16 v86, v112, v136 op_sel:[1,0] op_sel_hi:[1,1]
    v_pk_mul_f16 v87, v112, v137 op_sel:[1,0] op_sel_hi:[1,1]
    s_waitcnt lgkmcnt(2)
    v_mfma_f32_32x32x16_f16 v[48:63], v[160:163], v[80:83], v[48:63]
    ds_read_b128 v[156:159], v2 offset:96
    v_pk_mul_f16 v80, v104, v124 op_sel:[1,0] op_sel_hi:[1,1]
    v_pk_mul_f16 v81, v104, v125 op_sel:[1,0] op_sel_hi:[1,1]
    v_pk_mul_f16 v82, v104, v126 op_sel:[1,0] op_sel_hi:[1,1]
    v_pk_mul_f16 v83, v104, v127 op_sel:[1,0] op_sel_hi:[1,1]
    v_mfma_f32_32x32x16_f16 v[64:79], v[160:163], v[84:87], v[64:79]
    v_pk_mul_f16 v84, v112, v138 op_sel:[1,0] op_sel_hi:[1,1]
    v_pk_mul_f16 v85, v112, v139 op_sel:[1,0] op_sel_hi:[1,1]
    v_pk_mul_f16 v86, v112, v140 op_sel:[1,0] op_sel_hi:[1,1]
    v_pk_mul_f16 v87, v112, v141 op_sel:[1,0] op_sel_hi:[1,1]
    s_waitcnt lgkmcnt(2)
    v_mfma_f32_32x32x16_f16 v[48:63], v[148:151], v[80:83], v[48:63]
    ds_read_b128 v[160:163], v2 offset:112
    v_pk_mul_f16 v80, v104, v128 op_sel:[1,0] op_sel_hi:[1,1]
    v_pk_mul_f16 v81, v104, v129 op_sel:[1,0] op_sel_hi:[1,1]
    v_pk_mul_f16 v82, v104, v130 op_sel:[1,0] op_sel_hi:[1,1]
    v_pk_mul_f16 v83, v104, v131 op_sel:[1,0] op_sel_hi:[1,1]
    v_mfma_f32_32x32x16_f16 v[64:79], v[148:151], v[84:87], v[64:79]
    v_pk_mul_f16 v84, v112, v142 op_sel:[1,0] op_sel_hi:[1,1]
    v_pk_mul_f16 v85, v112, v143 op_sel:[1,0] op_sel_hi:[1,1]
    v_pk_mul_f16 v86, v112, v144 op_sel:[1,0] op_sel_hi:[1,1]
    v_pk_mul_f16 v87, v112, v145 op_sel:[1,0] op_sel_hi:[1,1]
    s_waitcnt lgkmcnt(2)
    v_mfma_f32_32x32x16_f16 v[48:63], v[152:155], v[80:83], v[48:63]
    ds_read_b128 v[148:151], v2 offset:128
    v_pk_mul_f16 v80, v104, v132 op_sel:[1,0] op_sel_hi:[1,1]
    v_pk_mul_f16 v81, v105, v122 op_sel:[0,0] op_sel_hi:[0,1]
    v_pk_mul_f16 v82, v105, v123 op_sel:[0,0] op_sel_hi:[0,1]
    v_pk_mul_f16 v83, v105, v124 op_sel:[0,0] op_sel_hi:[0,1]
    v_mfma_f32_32x32x16_f16 v[64:79], v[152:155], v[84:87], v[64:79]
    v_pk_mul_f16 v84, v112, v146 op_sel:[1,0] op_sel_hi:[1,1]
    v_pk_mul_f16 v85, v113, v136 op_sel:[0,0] op_sel_hi:[0,1]
    v_pk_mul_f16 v86, v113, v137 op_sel:[0,0] op_sel_hi:[0,1]
    v_pk_mul_f16 v87, v113, v138 op_sel:[0,0] op_sel_hi:[0,1]
    s_waitcnt lgkmcnt(2)
    v_mfma_f32_32x32x16_f16 v[48:63], v[156:159], v[80:83], v[48:63]
    ds_read_b128 v[152:155], v2 offset:144
    v_pk_mul_f16 v80, v105, v125 op_sel:[0,0] op_sel_hi:[0,1]
    v_pk_mul_f16 v81, v105, v126 op_sel:[0,0] op_sel_hi:[0,1]
    v_pk_mul_f16 v82, v105, v127 op_sel:[0,0] op_sel_hi:[0,1]
    v_pk_mul_f16 v83, v105, v128 op_sel:[0,0] op_sel_hi:[0,1]
    v_mfma_f32_32x32x16_f16 v[64:79], v[156:159], v[84:87], v[64:79]
    v_pk_mul_f16 v84, v113, v139 op_sel:[0,0] op_sel_hi:[0,1]
    v_pk_mul_f16 v85, v113, v140 op_sel:[0,0] op_sel_hi:[0,1]
    v_pk_mul_f16 v86, v113, v141 op_sel:[0,0] op_sel_hi:[0,1]
    v_pk_mul_f16 v87, v113, v142 op_sel:[0,0] op_sel_hi:[0,1]
    s_waitcnt lgkmcnt(2)
    v_mfma_f32_32x32x16_f16 v[48:63], v[160:163], v[80:83], v[48:63]
    ds_read_b128 v[156:159], v2 offset:160
    v_pk_mul_f16 v80, v105, v129 op_sel:[0,0] op_sel_hi:[0,1]
    v_pk_mul_f16 v81, v105, v130 op_sel:[0,0] op_sel_hi:[0,1]
    v_pk_mul_f16 v82, v105, v131 op_sel:[0,0] op_sel_hi:[0,1]
    v_pk_mul_f16 v83, v105, v132 op_sel:[0,0] op_sel_hi:[0,1]
    v_mfma_f32_32x32x16_f16 v[64:79], v[160:163], v[84:87], v[64:79]
    v_pk_mul_f16 v84, v113, v143 op_sel:[0,0] op_sel_hi:[0,1]
    v_pk_mul_f16 v85, v113, v144 op_sel:[0,0] op_sel_hi:[0,1]
    v_pk_mul_f16 v86, v113, v145 op_sel:[0,0] op_sel_hi:[0,1]
    v_pk_mul_f16 v87, v113, v146 op_sel:[0,0] op_sel_hi:[0,1]
    s_waitcnt lgkmcnt(2)
    v_mfma_f32_32x32x16_f16 v[48:63], v[148:151], v[80:83], v[48:63]
    ds_read_b128 v[160:163], v2 offset:176
    v_pk_mul_f16 v80, v105, v123 op_sel:[1,0] op_sel_hi:[1,1]
    v_pk_mul_f16 v81, v105, v124 op_sel:[1,0] op_sel_hi:[1,1]
    v_pk_mul_f16 v82, v105, v125 op_sel:[1,0] op_sel_hi:[1,1]
    v_pk_mul_f16 v83, v105, v126 op_sel:[1,0] op_sel_hi:[1,1]
    v_mfma_f32_32x32x16_f16 v[64:79], v[148:151], v[84:87], v[64:79]
    v_pk_mul_f16 v84, v113, v137 op_sel:[1,0] op_sel_hi:[1,1]
    v_pk_mul_f16 v85, v113, v138 op_sel:[1,0] op_sel_hi:[1,1]
    v_pk_mul_f16 v86, v113, v139 op_sel:[1,0] op_sel_hi:[1,1]
    v_pk_mul_f16 v87, v113, v140 op_sel:[1,0] op_sel_hi:[1,1]
    s_waitcnt lgkmcnt(2)
    v_mfma_f32_32x32x16_f16 v[48:63], v[152:155], v[80:83], v[48:63]
    ds_read_b128 v[148:151], v2 offset:192
    v_pk_mul_f16 v80, v105, v127 op_sel:[1,0] op_sel_hi:[1,1]
    v_pk_mul_f16 v81, v105, v128 op_sel:[1,0] op_sel_hi:[1,1]
    v_pk_mul_f16 v82, v105, v129 op_sel:[1,0] op_sel_hi:[1,1]
    v_pk_mul_f16 v83, v105, v130 op_sel:[1,0] op_sel_hi:[1,1]
    v_mfma_f32_32x32x16_f16 v[64:79], v[152:155], v[84:87], v[64:79]
    v_pk_mul_f16 v84, v113, v141 op_sel:[1,0] op_sel_hi:[1,1]
    v_pk_mul_f16 v85, v113, v142 op_sel:[1,0] op_sel_hi:[1,1]
    v_pk_mul_f16 v86, v113, v143 op_sel:[1,0] op_sel_hi:[1,1]
    v_pk_mul_f16 v87, v113, v144 op_sel:[1,0] op_sel_hi:[1,1]
    s_waitcnt lgkmcnt(2)
    v_mfma_f32_32x32x16_f16 v[48:63], v[156:159], v[80:83], v[48:63]
    ds_read_b128 v[152:155], v2 offset:208
    v_pk_mul_f16 v80, v105, v131 op_sel:[1,0] op_sel_hi:[1,1]
    v_pk_mul_f16 v81, v105, v132 op_sel:[1,0] op_sel_hi:[1,1]
    v_pk_mul_f16 v82, v106, v124 op_sel:[0,0] op_sel_hi:[0,1]
    v_pk_mul_f16 v83, v106, v125 op_sel:[0,0] op_sel_hi:[0,1]
    v_mfma_f32_32x32x16_f16 v[64:79], v[156:159], v[84:87], v[64:79]
    v_pk_mul_f16 v84, v113, v145 op_sel:[1,0] op_sel_hi:[1,1]
    v_pk_mul_f16 v85, v113, v146 op_sel:[1,0] op_sel_hi:[1,1]
    v_pk_mul_f16 v86, v114, v138 op_sel:[0,0] op_sel_hi:[0,1]
    v_pk_mul_f16 v87, v114, v139 op_sel:[0,0] op_sel_hi:[0,1]
    s_waitcnt lgkmcnt(2)
    v_mfma_f32_32x32x16_f16 v[48:63], v[160:163], v[80:83], v[48:63]
    ds_read_b128 v[156:159], v2 offset:224
    v_pk_mul_f16 v80, v106, v126 op_sel:[0,0] op_sel_hi:[0,1]
    v_pk_mul_f16 v81, v106, v127 op_sel:[0,0] op_sel_hi:[0,1]
    v_pk_mul_f16 v82, v106, v128 op_sel:[0,0] op_sel_hi:[0,1]
    v_pk_mul_f16 v83, v106, v129 op_sel:[0,0] op_sel_hi:[0,1]
    v_mfma_f32_32x32x16_f16 v[64:79], v[160:163], v[84:87], v[64:79]
    v_pk_mul_f16 v84, v114, v140 op_sel:[0,0] op_sel_hi:[0,1]
    v_pk_mul_f16 v85, v114, v141 op_sel:[0,0] op_sel_hi:[0,1]
    v_pk_mul_f16 v86, v114, v142 op_sel:[0,0] op_sel_hi:[0,1]
    v_pk_mul_f16 v87, v114, v143 op_sel:[0,0] op_sel_hi:[0,1]
    s_waitcnt lgkmcnt(2)
    v_mfma_f32_32x32x16_f16 v[48:63], v[148:151], v[80:83], v[48:63]
    ds_read_b128 v[160:163], v2 offset:240
    v_pk_mul_f16 v80, v106, v130 op_sel:[0,0] op_sel_hi:[0,1]
    v_pk_mul_f16 v81, v106, v131 op_sel:[0,0] op_sel_hi:[0,1]
    v_pk_mul_f16 v82, v106, v132 op_sel:[0,0] op_sel_hi:[0,1]
    v_pk_mul_f16 v83, v106, v125 op_sel:[1,0] op_sel_hi:[1,1]
    v_mfma_f32_32x32x16_f16 v[64:79], v[148:151], v[84:87], v[64:79]
    v_pk_mul_f16 v84, v114, v144 op_sel:[0,0] op_sel_hi:[0,1]
    v_pk_mul_f16 v85, v114, v145 op_sel:[0,0] op_sel_hi:[0,1]
    v_pk_mul_f16 v86, v114, v146 op_sel:[0,0] op_sel_hi:[0,1]
    v_pk_mul_f16 v87, v114, v139 op_sel:[1,0] op_sel_hi:[1,1]
    s_waitcnt lgkmcnt(2)
    v_mfma_f32_32x32x16_f16 v[48:63], v[152:155], v[80:83], v[48:63]
    ds_read_b128 v[148:151], v2 offset:256
    v_pk_mul_f16 v80, v106, v126 op_sel:[1,0] op_sel_hi:[1,1]
    v_pk_mul_f16 v81, v106, v127 op_sel:[1,0] op_sel_hi:[1,1]
    v_pk_mul_f16 v82, v106, v128 op_sel:[1,0] op_sel_hi:[1,1]
    v_pk_mul_f16 v83, v106, v129 op_sel:[1,0] op_sel_hi:[1,1]
    v_mfma_f32_32x32x16_f16 v[64:79], v[152:155], v[84:87], v[64:79]
    v_pk_mul_f16 v84, v114, v140 op_sel:[1,0] op_sel_hi:[1,1]
    v_pk_mul_f16 v85, v114, v141 op_sel:[1,0] op_sel_hi:[1,1]
    v_pk_mul_f16 v86, v114, v142 op_sel:[1,0] op_sel_hi:[1,1]
    v_pk_mul_f16 v87, v114, v143 op_sel:[1,0] op_sel_hi:[1,1]
    s_waitcnt lgkmcnt(2)
    v_mfma_f32_32x32x16_f16 v[48:63], v[156:159], v[80:83], v[48:63]
    ds_read_b128 v[152:155], v2 offset:272
    v_pk_mul_f16 v80, v106, v130 op_sel:[1,0] op_sel_hi:[1,1]
    v_pk_mul_f16 v81, v106, v131 op_sel:[1,0] op_sel_hi:[1,1]
    v_pk_mul_f16 v82, v106, v132 op_sel:[1,0] op_sel_hi:[1,1]
    v_pk_mul_f16 v83, v107, v126 op_sel:[0,0] op_sel_hi:[0,1]
    v_mfma_f32_32x32x16_f16 v[64:79], v[156:159], v[84:87], v[64:79]
    v_pk_mul_f16 v84, v114, v144 op_sel:[1,0] op_sel_hi:[1,1]
    v_pk_mul_f16 v85, v114, v145 op_sel:[1,0] op_sel_hi:[1,1]
    v_pk_mul_f16 v86, v114, v146 op_sel:[1,0] op_sel_hi:[1,1]
    v_pk_mul_f16 v87, v115, v140 op_sel:[0,0] op_sel_hi:[0,1]
    s_waitcnt lgkmcnt(2)
    v_mfma_f32_32x32x16_f16 v[48:63], v[160:163], v[80:83], v[48:63]
    ds_read_b128 v[156:159], v2 offset:288
    v_pk_mul_f16 v80, v107, v127 op_sel:[0,0] op_sel_hi:[0,1]
    v_pk_mul_f16 v81, v107, v128 op_sel:[0,0] op_sel_hi:[0,1]
    v_pk_mul_f16 v82, v107, v129 op_sel:[0,0] op_sel_hi:[0,1]
    v_pk_mul_f16 v83, v107, v130 op_sel:[0,0] op_sel_hi:[0,1]
    v_mfma_f32_32x32x16_f16 v[64:79], v[160:163], v[84:87], v[64:79]
    v_pk_mul_f16 v84, v115, v141 op_sel:[0,0] op_sel_hi:[0,1]
    v_pk_mul_f16 v85, v115, v142 op_sel:[0,0] op_sel_hi:[0,1]
    v_pk_mul_f16 v86, v115, v143 op_sel:[0,0] op_sel_hi:[0,1]
    v_pk_mul_f16 v87, v115, v144 op_sel:[0,0] op_sel_hi:[0,1]
    s_waitcnt lgkmcnt(2)
    v_mfma_f32_32x32x16_f16 v[48:63], v[148:151], v[80:83], v[48:63]
    ds_read_b128 v[160:163], v2 offset:304
    v_pk_mul_f16 v80, v107, v131 op_sel:[0,0] op_sel_hi:[0,1]
    v_pk_mul_f16 v81, v107, v132 op_sel:[0,0] op_sel_hi:[0,1]
    v_pk_mul_f16 v82, v107, v127 op_sel:[1,0] op_sel_hi:[1,1]
    v_pk_mul_f16 v83, v107, v128 op_sel:[1,0] op_sel_hi:[1,1]
    v_mfma_f32_32x32x16_f16 v[64:79], v[148:151], v[84:87], v[64:79]
    v_pk_mul_f16 v84, v115, v145 op_sel:[0,0] op_sel_hi:[0,1]
    v_pk_mul_f16 v85, v115, v146 op_sel:[0,0] op_sel_hi:[0,1]
    v_pk_mul_f16 v86, v115, v141 op_sel:[1,0] op_sel_hi:[1,1]
    v_pk_mul_f16 v87, v115, v142 op_sel:[1,0] op_sel_hi:[1,1]
    s_waitcnt lgkmcnt(2)
    v_mfma_f32_32x32x16_f16 v[48:63], v[152:155], v[80:83], v[48:63]
    ds_read_b128 v[148:151], v2 offset:320
    v_pk_mul_f16 v80, v107, v129 op_sel:[1,0] op_sel_hi:[1,1]
    v_pk_mul_f16 v81, v107, v130 op_sel:[1,0] op_sel_hi:[1,1]
    v_pk_mul_f16 v82, v107, v131 op_sel:[1,0] op_sel_hi:[1,1]
    v_pk_mul_f16 v83, v107, v132 op_sel:[1,0] op_sel_hi:[1,1]
    v_mfma_f32_32x32x16_f16 v[64:79], v[152:155], v[84:87], v[64:79]
    v_pk_mul_f16 v84, v115, v143 op_sel:[1,0] op_sel_hi:[1,1]
    v_pk_mul_f16 v85, v115, v144 op_sel:[1,0] op_sel_hi:[1,1]
    v_pk_mul_f16 v86, v115, v145 op_sel:[1,0] op_sel_hi:[1,1]
    v_pk_mul_f16 v87, v115, v146 op_sel:[1,0] op_sel_hi:[1,1]
    s_waitcnt lgkmcnt(2)
    v_mfma_f32_32x32x16_f16 v[48:63], v[156:159], v[80:83], v[48:63]
    ds_read_b128 v[152:155], v2 offset:336
    v_pk_mul_f16 v80, v108, v128 op_sel:[0,0] op_sel_hi:[0,1]
    v_pk_mul_f16 v81, v108, v129 op_sel:[0,0] op_sel_hi:[0,1]
    v_pk_mul_f16 v82, v108, v130 op_sel:[0,0] op_sel_hi:[0,1]
    v_pk_mul_f16 v83, v108, v131 op_sel:[0,0] op_sel_hi:[0,1]
    v_mfma_f32_32x32x16_f16 v[64:79], v[156:159], v[84:87], v[64:79]
    v_pk_mul_f16 v84, v116, v142 op_sel:[0,0] op_sel_hi:[0,1]
    v_pk_mul_f16 v85, v116, v143 op_sel:[0,0] op_sel_hi:[0,1]
    v_pk_mul_f16 v86, v116, v144 op_sel:[0,0] op_sel_hi:[0,1]
    v_pk_mul_f16 v87, v116, v145 op_sel:[0,0] op_sel_hi:[0,1]
    s_waitcnt lgkmcnt(2)
    v_mfma_f32_32x32x16_f16 v[48:63], v[160:163], v[80:83], v[48:63]
    ds_read_b128 v[156:159], v2 offset:352
    v_pk_mul_f16 v80, v108, v132 op_sel:[0,0] op_sel_hi:[0,1]
    v_pk_mul_f16 v81, v108, v129 op_sel:[1,0] op_sel_hi:[1,1]
    v_pk_mul_f16 v82, v108, v130 op_sel:[1,0] op_sel_hi:[1,1]
    v_pk_mul_f16 v83, v108, v131 op_sel:[1,0] op_sel_hi:[1,1]
    v_mfma_f32_32x32x16_f16 v[64:79], v[160:163], v[84:87], v[64:79]
    v_pk_mul_f16 v84, v116, v146 op_sel:[0,0] op_sel_hi:[0,1]
    v_pk_mul_f16 v85, v116, v143 op_sel:[1,0] op_sel_hi:[1,1]
    v_pk_mul_f16 v86, v116, v144 op_sel:[1,0] op_sel_hi:[1,1]
    v_pk_mul_f16 v87, v116, v145 op_sel:[1,0] op_sel_hi:[1,1]
    s_waitcnt lgkmcnt(2)
    v_mfma_f32_32x32x16_f16 v[48:63], v[148:151], v[80:83], v[48:63]
    ds_read_b128 v[160:163], v2 offset:368
    v_pk_mul_f16 v80, v108, v132 op_sel:[1,0] op_sel_hi:[1,1]
    v_pk_mul_f16 v81, v109, v130 op_sel:[0,0] op_sel_hi:[0,1]
    v_pk_mul_f16 v82, v109, v131 op_sel:[0,0] op_sel_hi:[0,1]
    v_pk_mul_f16 v83, v109, v132 op_sel:[0,0] op_sel_hi:[0,1]
    v_mfma_f32_32x32x16_f16 v[64:79], v[148:151], v[84:87], v[64:79]
    v_pk_mul_f16 v84, v116, v146 op_sel:[1,0] op_sel_hi:[1,1]
    v_pk_mul_f16 v85, v117, v144 op_sel:[0,0] op_sel_hi:[0,1]
    v_pk_mul_f16 v86, v117, v145 op_sel:[0,0] op_sel_hi:[0,1]
    v_pk_mul_f16 v87, v117, v146 op_sel:[0,0] op_sel_hi:[0,1]
    s_waitcnt lgkmcnt(2)
    v_mfma_f32_32x32x16_f16 v[48:63], v[152:155], v[80:83], v[48:63]
    ds_read_b128 v[148:151], v2 offset:384
    v_pk_mul_f16 v80, v109, v131 op_sel:[1,0] op_sel_hi:[1,1]
    v_pk_mul_f16 v81, v109, v132 op_sel:[1,0] op_sel_hi:[1,1]
    v_pk_mul_f16 v82, v110, v132 op_sel:[0,0] op_sel_hi:[0,1]
    v_mov_b32 v83, 0
    v_mfma_f32_32x32x16_f16 v[64:79], v[152:155], v[84:87], v[64:79]
    v_pk_mul_f16 v84, v117, v145 op_sel:[1,0] op_sel_hi:[1,1]
    v_pk_mul_f16 v85, v117, v146 op_sel:[1,0] op_sel_hi:[1,1]
    v_pk_mul_f16 v86, v118, v146 op_sel:[0,0] op_sel_hi:[0,1]
    v_mov_b32 v87, 0
    s_waitcnt lgkmcnt(2)
    v_mfma_f32_32x32x16_f16 v[48:63], v[156:159], v[80:83], v[48:63]
    v_mfma_f32_32x32x16_f16 v[64:79], v[156:159], v[84:87], v[64:79]
    s_waitcnt lgkmcnt(1)
    v_mfma_f32_32x32x16_f16 v[48:63], v[160:163], v[104:107], v[48:63]
    v_mfma_f32_32x32x16_f16 v[64:79], v[160:163], v[112:115], v[64:79]
    s_waitcnt lgkmcnt(0)
    v_mfma_f32_32x32x16_f16 v[48:63], v[148:151], v[108:111], v[48:63]
    v_mfma_f32_32x32x16_f16 v[64:79], v[148:151], v[116:119], v[64:79]
    ds_read_b32 v167, v165 offset:56
    v_add_f32 v5, v5, v29
    v_mul_f32 v5, 0x43000000, v5
    v_add_f32 v6, v6, v45
    v_mul_f32 v6, 0x43000000, v6
    s_nop 6
    v_fmac_f32 v5, v48, v16
    v_fmac_f32 v5, v49, v17
    v_fmac_f32 v5, v50, v18
    v_fmac_f32 v5, v51, v19
    v_fmac_f32 v5, v52, v20
    v_fmac_f32 v5, v53, v21
    v_fmac_f32 v5, v54, v22
    v_fmac_f32 v5, v55, v23
    v_fmac_f32 v5, v56, v24
    v_fmac_f32 v5, v57, v25
    v_fmac_f32 v5, v58, v26
    v_fmac_f32 v5, v59, v27
    v_fmac_f32 v5, v60, v28
    v_max3_f32 v8, abs(v48), abs(v49), abs(v50)
    v_max3_f32 v8, abs(v51), abs(v52), v8
    v_fmac_f32 v6, v64, v32
    v_fmac_f32 v6, v65, v33
    v_fmac_f32 v6, v66, v34
    v_fmac_f32 v6, v67, v35
    v_fmac_f32 v6, v68, v36
    v_fmac_f32 v6, v69, v37
    v_fmac_f32 v6, v70, v38
    v_fmac_f32 v6, v71, v39
    v_fmac_f32 v6, v72, v40
    v_fmac_f32 v6, v73, v41
    v_fmac_f32 v6, v74, v42
    v_fmac_f32 v6, v75, v43
    v_fmac_f32 v6, v76, v44
    v_max3_f32 v9, abs(v64), abs(v65), abs(v66)
    v_max3_f32 v9, abs(v67), abs(v68), v9
    v_min3_f32 v7, v7, v8, v9
    v_add_f32 v8, v5, v6
    v_mov_b32 v9, 0x207
    v_cmp_nle_f32 vcc, 0x38800000, v7
    v_cmp_class_f32 s[40:41], v8, v9
    s_waitcnt lgkmcnt(0)
    v_readfirstlane_b32 s44, v167
    s_or_b64 s[40:41], s[40:41], vcc
    s_or_b32 s40, s40, s41
    s_or_b32 s40, s40, s44
    s_cmp_lg_u32 s40, 0
    s_cbranch_scc1 L_slow
    s_nop 0
    v_add_f32_dpp v5, v5, v5 row_shr:1 row_mask:0xf bank_mask:0xf bound_ctrl:0
    v_add_f32_dpp v6, v6, v6 row_shr:1 row_mask:0xf bank_mask:0xf bound_ctrl:0
    s_nop 0
    v_add_f32_dpp v5, v5, v5 row_shr:2 row_mask:0xf bank_mask:0xf bound_ctrl:0
    v_add_f32_dpp v6, v6, v6 row_shr:2 row_mask:0xf bank_mask:0xf bound_ctrl:0
    s_nop 0
    v_add_f32_dpp v5, v5, v5 row_shr:4 row_mask:0xf bank_mask:0xf bound_ctrl:0
    v_add_f32_dpp v6, v6, v6 row_shr:4 row_mask:0xf bank_mask:0xf bound_ctrl:0
    s_nop 0
    v_add_f32_dpp v5, v5, v5 row_shr:8 row_mask:0xf bank_mask:0xf bound_ctrl:0
    v_add_f32_dpp v6, v6, v6 row_shr:8 row_mask:0xf bank_mask:0xf bound_ctrl:0
    v_mul_f32 v5, 0x3b800000, v5
    v_mul_f32 v6, 0x3b800000, v6
    s_mov_b32 exec_lo, 0x80008000
    s_mov_b32 exec_hi, 0x80008000
    ds_write_b32 v13, v5
    ds_write_b32 v13, v6 offset:16
    s_mov_b64 exec, -1
    s_waitcnt lgkmcnt(0)
    s_mov_b64 exec, 1
    ds_add_u32 v165, v166 offset:44
    s_mov_b64 exec, -1
    s_endpgm
L_slow:
    s_setprio 0
    v_lshrrev_b32 v2, 4, v1
    s_lshl_b32 s40, s59, 4
    s_lshl_b32 s41, s3, 2
    s_add_u32 s40, s40, s41
    v_add_u32 v2, s40, v2
    v_mul_u32_u24 v2, 104, v2
    global_load_dword v48, v2, s[16:17] offset:0
    global_load_dword v49, v2, s[16:17] offset:4
    global_load_dword v50, v2, s[16:17] offset:8
    global_load_dword v51, v2, s[16:17] offset:12
    global_load_dword v52, v2, s[16:17] offset:16
    global_load_dword v53, v2, s[16:17] offset:20
    global_load_dword v54, v2, s[16:17] offset:24
    global_load_dword v55, v2, s[16:17] offset:28
    global_load_dword v56, v2, s[16:17] offset:32
    global_load_dword v57, v2, s[16:17] offset:36
    global_load_dword v58, v2, s[16:17] offset:40
    global_load_dword v59, v2, s[16:17] offset:44
    global_load_dword v60, v2, s[16:17] offset:48
    global_load_dword v61, v2, s[16:17] offset:52
    global_load_dword v62, v2, s[16:17] offset:56
    global_load_dword v63, v2, s[16:17] offset:60
    global_load_dword v64, v2, s[16:17] offset:64
    global_load_dword v65, v2, s[16:17] offset:68
    global_load_dword v66, v2, s[16:17] offset:72
    global_load_dword v67, v2, s[16:17] offset:76
    global_load_dword v68, v2, s[16:17] offset:80
    global_load_dword v69, v2, s[16:17] offset:84
    global_load_dword v70, v2, s[16:17] offset:88
    global_load_dword v71, v2, s[16:17] offset:92
    global_load_dword v72, v2, s[16:17] offset:96
    global_load_dword v73, v2, s[16:17] offset:100
    v_and_b32 v3, 15, v1
    v_lshlrev_b32 v3, 1, v3
    s_mul_i32 s40, s3, 13312
    v_lshlrev_b32 v4, 2, v1
    v_add_u32 v4, s40, v4
    v_add_u32 v5, 6656, v4
    s_waitcnt vmcnt(0)
    v_lshl_add_u32 v48, v48, 5, v3
    buffer_load_ushort v16, v48, s[8:11], 0 offen
    v_lshl_add_u32 v49, v49, 5, v3
    buffer_load_ushort v17, v49, s[8:11], 0 offen
    v_lshl_add_u32 v50, v50, 5, v3
    buffer_load_ushort v18, v50, s[8:11], 0 offen
    v_lshl_add_u32 v51, v51, 5, v3
    buffer_load_ushort v19, v51, s[8:11], 0 offen
    v_lshl_add_u32 v52, v52, 5, v3
    buffer_load_ushort v20, v52, s[8:11], 0 offen
    v_lshl_add_u32 v53, v53, 5, v3
    buffer_load_ushort v21, v53, s[8:11], 0 offen
    v_lshl_add_u32 v54, v54, 5, v3
    buffer_load_ushort v22, v54, s[8:11], 0 offen
    v_lshl_add_u32 v55, v55, 5, v3
    buffer_load_ushort v23, v55, s[8:11], 0 offen
    v_lshl_add_u32 v56, v56, 5, v3
    buffer_load_ushort v24, v56, s[8:11], 0 offen
    v_lshl_add_u32 v57, v57, 5, v3
    buffer_load_ushort v25, v57, s[8:11], 0 offen
    v_lshl_add_u32 v58, v58, 5, v3
    buffer_load_ushort v26, v58, s[8:11], 0 offen
    v_lshl_add_u32 v59, v59, 5, v3
    buffer_load_ushort v27, v59, s[8:11], 0 offen
    v_lshl_add_u32 v60, v60, 5, v3
    buffer_load_ushort v28, v60, s[8:11], 0 offen
    v_lshl_add_u32 v61, v61, 5, v3
    buffer_load_ushort v29, v61, s[8:11], 0 offen
    v_lshl_add_u32 v62, v62, 5, v3
    buffer_load_ushort v30, v62, s[8:11], 0 offen
    v_lshl_add_u32 v63, v63, 5, v3
    buffer_load_ushort v31, v63, s[8:11], 0 offen
    v_lshl_add_u32 v64, v64, 5, v3
    buffer_load_ushort v32, v64, s[8:11], 0 offen
    v_lshl_add_u32 v65, v65, 5, v3
    buffer_load_ushort v33, v65, s[8:11], 0 offen
    v_lshl_add_u32 v66, v66, 5, v3
    buffer_load_ushort v34, v66, s[8:11], 0 offen
    v_lshl_add_u32 v67, v67, 5, v3
    buffer_load_ushort v35, v67, s[8:11], 0 offen
    v_lshl_add_u32 v68, v68, 5, v3
    buffer_load_ushort v36, v68, s[8:11], 0 offen
    v_lshl_add_u32 v69, v69, 5, v3
    buffer_load_ushort v37, v69, s[8:11], 0 offen
    v_lshl_add_u32 v70, v70, 5, v3
    buffer_load_ushort v38, v70, s[8:11], 0 offen
    v_lshl_add_u32 v71, v71, 5, v3
    buffer_load_ushort v39, v71, s[8:11], 0 offen
    v_lshl_add_u32 v72, v72, 5, v3
    buffer_load_ushort v40, v72, s[8:11], 0 offen
    v_lshl_add_u32 v73, v73, 5, v3
    buffer_load_ushort v41, v73, s[8:11], 0 offen
    s_waitcnt vmcnt(0)
    v_lshlrev_b32 v16, 16, v16
    ds_write_b32 v4, v16 offset:0
    v_lshlrev_b32 v17, 16, v17
    ds_write_b32 v4, v17 offset:256
    v_lshlrev_b32 v18, 16, v18
    ds_write_b32 v4, v18 offset:512
    v_lshlrev_b32 v19, 16, v19
    ds_write_b32 v4, v19 offset:768
    v_lshlrev_b32 v20, 16, v20
    ds_write_b32 v4, v20 offset:1024
    v_lshlrev_b32 v21, 16, v21
    ds_write_b32 v4, v21 offset:1280
    v_lshlrev_b32 v22, 16, v22
    ds_write_b32 v4, v22 offset:1536
    v_lshlrev_b32 v23, 16, v23
    ds_write_b32 v4, v23 offset:1792
    v_lshlrev_b32 v24, 16, v24
    ds_write_b32 v4, v24 offset:2048
    v_lshlrev_b32 v25, 16, v25
    ds_write_b32 v4, v25 offset:2304
    v_lshlrev_b32 v26, 16, v26
    ds_write_b32 v4, v26 offset:2560
    v_lshlrev_b32 v27, 16, v27
    ds_write_b32 v4, v27 offset:2816
    v_lshlrev_b32 v28, 16, v28
    ds_write_b32 v4, v28 offset:3072
    v_lshlrev_b32 v29, 16, v29
    ds_write_b32 v4, v29 offset:3328
    v_lshlrev_b32 v30, 16, v30
    ds_write_b32 v4, v30 offset:3584
    v_lshlrev_b32 v31, 16, v31
    ds_write_b32 v4, v31 offset:3840
    v_lshlrev_b32 v32, 16, v32
    ds_write_b32 v4, v32 offset:4096
    v_lshlrev_b32 v33, 16, v33
    ds_write_b32 v4, v33 offset:4352
    v_lshlrev_b32 v34, 16, v34
    ds_write_b32 v4, v34 offset:4608
    v_lshlrev_b32 v35, 16, v35
    ds_write_b32 v4, v35 offset:4864
    v_lshlrev_b32 v36, 16, v36
    ds_write_b32 v4, v36 offset:5120
    v_lshlrev_b32 v37, 16, v37
    ds_write_b32 v4, v37 offset:5376
    v_lshlrev_b32 v38, 16, v38
    ds_write_b32 v4, v38 offset:5632
    v_lshlrev_b32 v39, 16, v39
    ds_write_b32 v4, v39 offset:5888
    v_lshlrev_b32 v40, 16, v40
    ds_write_b32 v4, v40 offset:6144
    v_lshlrev_b32 v41, 16, v41
    ds_write_b32 v4, v41 offset:6400
    v_mov_b32 v6, 0
    s_mov_b32 s80, 0
    s_mov_b32 s83, 0
    s_mov_b32 s82, 0
L_sl_l:
    s_mov_b32 s81, 0
    v_mov_b32 v9, v5
L_sl_h:
    s_lshr_b32 s40, s83, 1
    s_lshl_b32 s40, s40, 2
    s_load_dword s77, s[22:23], s40
    v_mov_b32 v7, 0
    v_mov_b32 v8, v4
    s_mov_b32 s84, 0
L_sl_i:
    s_load_dwordx8 s[64:71], s[20:21], s80
    s_add_u32 s40, s80, 32
    s_load_dwordx4 s[72:75], s[20:21], s40
    s_add_u32 s40, s80, 48
    s_load_dword s76, s[20:21], s40
    ds_read_b32 v10, v8
    v_add_u32 v8, 256, v8
    s_add_u32 s80, s80, 52
    s_waitcnt lgkmcnt(0)
    s_lshl_b32 s78, s64, 16
    s_and_b32 s79, s64, 0xffff0000
    v_mul_f32 v11, s78, v16
    v_fmac_f32 v11, s79, v17
    s_lshl_b32 s78, s65, 16
    s_and_b32 s79, s65, 0xffff0000
    v_fmac_f32 v11, s78, v18
    v_fmac_f32 v11, s79, v19
    s_lshl_b32 s78, s66, 16
    s_and_b32 s79, s66, 0xffff0000
    v_fmac_f32 v11, s78, v20
    v_fmac_f32 v11, s79, v21
    s_lshl_b32 s78, s67, 16
    s_and_b32 s79, s67, 0xffff0000
    v_fmac_f32 v11, s78, v22
    v_fmac_f32 v11, s79, v23
    s_lshl_b32 s78, s68, 16
    s_and_b32 s79, s68, 0xffff0000
    v_fmac_f32 v11, s78, v24
    v_fmac_f32 v11, s79, v25
    s_lshl_b32 s78, s69, 16
    s_and_b32 s79, s69, 0xffff0000
    v_fmac_f32 v11, s78, v26
    v_fmac_f32 v11, s79, v27
    s_lshl_b32 s78, s70, 16
    s_and_b32 s79, s70, 0xffff0000
    v_fmac_f32 v11, s78, v28
    v_fmac_f32 v11, s79, v29
    s_lshl_b32 s78, s71, 16
    s_and_b32 s79, s71, 0xffff0000
    v_fmac_f32 v11, s78, v30
    v_fmac_f32 v11, s79, v31
    s_lshl_b32 s78, s72, 16
    s_and_b32 s79, s72, 0xffff0000
    v_fmac_f32 v11, s78, v32
    v_fmac_f32 v11, s79, v33
    s_lshl_b32 s78, s73, 16
    s_and_b32 s79, s73, 0xffff0000
    v_fmac_f32 v11, s78, v34
    v_fmac_f32 v11, s79, v35
    s_lshl_b32 s78, s74, 16
    s_and_b32 s79, s74, 0xffff0000
    v_fmac_f32 v11, s78, v36
    v_fmac_f32 v11, s79, v37
    s_lshl_b32 s78, s75, 16
    s_and_b32 s79, s75, 0xffff0000
    v_fmac_f32 v11, s78, v38
    v_fmac_f32 v11, s79, v39
    s_lshl_b32 s78, s76, 16
    s_and_b32 s79, s76, 0xffff0000
    v_fmac_f32 v11, s78, v40
    v_fmac_f32 v11, s79, v41
    v_fmac_f32 v7, v11, v10
    s_add_u32 s84, s84, 1
    s_cmp_lt_u32 s84, 26
    s_cbranch_scc1 L_sl_i
    ds_write_b32 v9, v7
    v_add_u32 v9, 256, v9
    s_lshl_b32 s78, s77, 16
    s_and_b32 s79, s77, 0xffff0000
    s_bitcmp1_b32 s83, 0
    s_cselect_b32 s78, s79, s78
    v_fmac_f32 v6, s78, v7
    s_add_u32 s83, s83, 1
    s_add_u32 s81, s81, 1
    s_cmp_lt_u32 s81, 26
    s_cbranch_scc1 L_sl_h
    v_mov_b32 v9, v4
    v_mov_b32 v4, v5
    v_mov_b32 v5, v9
    s_add_u32 s82, s82, 1
    s_cmp_lt_u32 s82, 6
    s_cbranch_scc1 L_sl_l
    s_nop 1
    v_add_f32_dpp v6, v6, v6 row_shr:1 row_mask:0xf bank_mask:0xf bound_ctrl:0
    s_nop 1
    v_add_f32_dpp v6, v6, v6 row_shr:2 row_mask:0xf bank_mask:0xf bound_ctrl:0
    s_nop 1
    v_add_f32_dpp v6, v6, v6 row_shr:4 row_mask:0xf bank_mask:0xf bound_ctrl:0
    s_nop 1
    v_add_f32_dpp v6, v6, v6 row_shr:8 row_mask:0xf bank_mask:0xf bound_ctrl:0
    v_lshrrev_b32 v2, 4, v1
    s_lshl_b32 s40, s3, 5
    s_add_u32 s40, s40, 163136
    v_lshl_add_u32 v2, v2, 3, s40
    v_mov_b32 v7, 0
    s_mov_b32 exec_lo, 0x80008000
    s_mov_b32 exec_hi, 0x80008000
    ds_write_b64 v2, v[6:7]
    s_mov_b64 exec, -1
    s_waitcnt lgkmcnt(0)
    s_mov_b64 exec, 1
    ds_add_u32 v165, v166 offset:44
    s_mov_b64 exec, -1
    s_endpgm
L_H1:
    global_load_dword v124, v2, s[38:39]
    s_mul_i32 s46, s57, 3
    s_add_u32 s46, s46, s47
    s_cmp_eq_u32 s57, 0
    s_cselect_b32 s40, 12, 13
    s_cmp_eq_u32 s47, 3
    s_cselect_b32 s46, s40, s46
    s_and_b32 s43, s47, 1
    s_lshr_b32 s44, s47, 1
    s_lshl_b32 s40, s56, 1
    s_add_u32 s40, s40, s43
    s_mul_i32 s40, s40, 3328
    v_and_b32 v8, 31, v1
    v_mul_u32_u24 v2, 104, v8
    v_add_u32 v2, s40, v2
    s_lshl_b32 s41, s44, 4
    v_add_u32 v3, s41, v2
    s_lshl_b32 s41, s44, 3
    v_add_u32 v4, s41, v2
    global_load_dwordx4 v[100:103], v3, s[16:17]
    global_load_dwordx4 v[104:107], v3, s[16:17] offset:32
    global_load_dwordx2 v[108:109], v4, s[16:17] offset:64
    s_min_u32 s40, s46, 12
    s_lshl_b32 s40, s40, 6
    v_lshl_add_u32 v8, v8, 1, s40
    global_load_ushort v120, v8, s[26:27]
    global_load_ushort v121, v8, s[28:29]
    s_waitcnt vmcnt(9)
    v_lshlrev_b32 v12, 16, v148
    v_and_b32 v13, 0xffff0000, v148
    v_cvt_pk_f16_f32 v148, v12, v13
    v_lshlrev_b32 v14, 16, v149
    v_and_b32 v15, 0xffff0000, v149
    v_cvt_pk_f16_f32 v149, v14, v15
    v_lshlrev_b32 v12, 16, v150
    v_and_b32 v13, 0xffff0000, v150
    v_cvt_pk_f16_f32 v150, v12, v13
    v_lshlrev_b32 v14, 16, v151
    v_and_b32 v15, 0xffff0000, v151
    v_cvt_pk_f16_f32 v151, v14, v15
    ds_write_b128 v160, v[148:151] offset:0
    s_waitcnt vmcnt(8)
    v_lshlrev_b32 v12, 16, v152
    v_and_b32 v13, 0xffff0000, v152
    v_cvt_pk_f16_f32 v152, v12, v13
    v_lshlrev_b32 v14, 16, v153
    v_and_b32 v15, 0xffff0000, v153
    v_cvt_pk_f16_f32 v153, v14, v15
    v_lshlrev_b32 v12, 16, v154
    v_and_b32 v13, 0xffff0000, v154
    v_cvt_pk_f16_f32 v154, v12, v13
    v_lshlrev_b32 v14, 16, v155
    v_and_b32 v15, 0xffff0000, v155
    v_cvt_pk_f16_f32 v155, v14, v15
    v_max3_f32 v12, abs(v12), abs(v13), abs(v14)
    v_cmp_le_f32 vcc, 0x3a800000, v12
    s_cbranch_vccnz L_wok14
    s_mov_b64 exec, 1
    ds_add_u32 v165, v166 offset:56
    s_mov_b64 exec, -1
L_wok14:
    ds_write_b128 v160, v[152:155] offset:12288
    s_waitcnt vmcnt(7)
    v_lshlrev_b32 v12, 16, v156
    v_and_b32 v13, 0xffff0000, v156
    v_cvt_pk_f16_f32 v156, v12, v13
    v_lshlrev_b32 v14, 16, v157
    v_and_b32 v15, 0xffff0000, v157
    v_cvt_pk_f16_f32 v157, v14, v15
    v_lshlrev_b32 v12, 16, v158
    v_and_b32 v13, 0xffff0000, v158
    v_cvt_pk_f16_f32 v158, v12, v13
    v_lshlrev_b32 v14, 16, v159
    v_and_b32 v15, 0xffff0000, v159
    v_cvt_pk_f16_f32 v159, v14, v15
    ds_write_b128 v160, v[156:159] offset:24576
    s_waitcnt lgkmcnt(0)
    s_mov_b64 exec, 1
    ds_add_u32 v165, v166 offset:0
    s_mov_b64 exec, -1
    s_cmp_lg_u32 s47, 0
    s_cbranch_scc1 L_nog13
    s_mov_b32 m0, 53248
    s_nop 0
    buffer_load_dwordx4 v162, s[8:11], 0 offen lds
L_nog13:
    s_mul_i32 s58, s47, 5120
    s_add_u32 s58, s58, 40960
    v_lshrrev_b32 v3, 2, v1
    v_mul_u32_u24 v112, 832, v3
    v_and_b32 v4, 3, v1
    v_lshl_add_u32 v112, v4, 4, v112
    s_lshl_b32 s40, s46, 6
    v_add_u32 v112, s40, v112
    v_lshrrev_b32 v2, 5, v1
    v_bfe_u32 v3, v1, 4, 1
    v_bfe_u32 v5, v1, 2, 2
    v_lshlrev_b32 v4, 3, v4
    v_lshl_add_u32 v6, v2, 3, v5
    v_lshl_add_u32 v7, v3, 5, v4
    v_lshl_add_u32 v113, v6, 6, v7
    v_add_u32 v113, s58, v113
    v_lshlrev_b32 v115, 4, v2
    v_lshlrev_b32 v114, 4, v1
    v_add_u32 v110, 61440, v114
    s_lshl_b32 s40, s47, 8
    s_add_u32 s40, s40, 162112
    v_lshl_add_u32 v116, v1, 2, s40
    v_add_u32 v117, s40, v115
    v_mov_b32 v118, 0
    v_mov_b32 v119, 0
    s_waitcnt vmcnt(0)
    s_waitcnt lgkmcnt(0)
    s_mov_b64 exec, 1
    ds_add_u32 v165, v166 offset:8
    s_mov_b64 exec, -1
    v_and_b32 v130, 0xff, v124
    v_bfe_u32 v131, v124, 8, 8
    v_bfe_u32 v132, v124, 16, 8
    v_lshrrev_b32 v133, 28, v124
    v_mul_u32_u24 v125, 104, v130
    v_lshl_add_u32 v125, v131, 2, v125
    v_mul_u32_u24 v126, 104, v131
    v_lshl_add_u32 v126, v130, 2, v126
    v_mul_u32_u24 v130, 1352, v133
    v_add_u32 v130, 85360, v130
    v_add_u32 v125, v125, v130
    v_add_u32 v126, v126, v130
    v_mul_u32_u24 v130, 816, v133
    v_lshl_add_u32 v127, v132, 2, v130
    v_add_u32 v127, 63072, v127
    v_bfe_u32 v131, v124, 24, 1
    v_mov_b32 v130, 0x0c0c0c0c
    v_cmp_eq_u32 vcc, 0, v131
    v_mov_b32 v128, 0x05040100
    v_mov_b32 v129, 0x07060302
    v_cndmask_b32 v128, v130, v128, vcc
    v_cndmask_b32 v129, v130, v129, vcc
    v_lshl_add_u32 v100, v100, 5, v115
    v_lshl_add_u32 v101, v101, 5, v115
    v_lshl_add_u32 v102, v102, 5, v115
    v_lshl_add_u32 v103, v103, 5, v115
    v_lshl_add_u32 v104, v104, 5, v115
    v_lshl_add_u32 v105, v105, 5, v115
    v_lshl_add_u32 v106, v106, 5, v115
    v_lshl_add_u32 v107, v107, 5, v115
    v_lshl_add_u32 v108, v108, 5, v115
    v_lshl_add_u32 v109, v109, 5, v115
    v_cmp_gt_u32 vcc, 32, v1
    s_lshl_b32 s43, s43, 10
    s_lshl_b32 s45, s44, 13
    v_cndmask_b32 v120, v121, v120, vcc
    v_lshlrev_b32 v120, 16, v120
    ds_write_b32 v116, v120
    s_add_u32 s45, s45, s43
    s_lshl_b32 s44, s44, 12
    s_add_u32 s44, s44, s43
    s_branch L_wf16
L_wf15:
    s_sleep 1
L_wf16:
    ds_read_b32 v167, v165 offset:0
    s_waitcnt lgkmcnt(0)
    v_readfirstlane_b32 s40, v167
    s_cmp_lt_u32 s40, 12
    s_cbranch_scc1 L_wf15
    ds_read_b32 v130, v125 offset:0
    ds_read_b32 v131, v125 offset:52
    ds_read_b32 v132, v126 offset:0
    ds_read_b32 v133, v126 offset:52
    ds_read_b32 v134, v125 offset:5408
    ds_read_b32 v135, v125 offset:5460
    ds_read_b32 v136, v126 offset:5408
    ds_read_b32 v137, v126 offset:5460
    s_waitcnt lgkmcnt(4)
    v_perm_b32 v142, v133, v132, v128
    v_perm_b32 v143, v133, v132, v129
    v_pk_add_f16 v142, v130, v142
    v_pk_add_f16 v143, v131, v143
    ds_read_b32 v138, v125 offset:10816
    ds_read_b32 v139, v125 offset:10868
    ds_read_b32 v140, v126 offset:10816
    ds_read_b32 v141, v126 offset:10868
    ds_write_b32 v127, v142 offset:0
    ds_write_b32 v127, v143 offset:400
    s_waitcnt lgkmcnt(6)
    v_perm_b32 v144, v137, v136, v128
    v_perm_b32 v145, v137, v136, v129
    v_pk_add_f16 v144, v134, v144
    v_pk_add_f16 v145, v135, v145
    ds_read_b32 v130, v125 offset:16224
    ds_read_b32 v131, v125 offset:16276
    ds_read_b32 v132, v126 offset:16224
    ds_read_b32 v133, v126 offset:16276
    ds_write_b32 v127, v144 offset:3264
    ds_write_b32 v127, v145 offset:3664
    s_waitcnt lgkmcnt(8)
    v_perm_b32 v142, v141, v140, v128
    v_perm_b32 v143, v141, v140, v129
    v_pk_add_f16 v142, v138, v142
    v_pk_add_f16 v143, v139, v143
    ds_read_b32 v134, v125 offset:21632
    ds_read_b32 v135, v125 offset:21684
    ds_read_b32 v136, v126 offset:21632
    ds_read_b32 v137, v126 offset:21684
    ds_write_b32 v127, v142 offset:6528
    ds_write_b32 v127, v143 offset:6928
    s_waitcnt lgkmcnt(8)
    v_perm_b32 v144, v133, v132, v128
    v_perm_b32 v145, v133, v132, v129
    v_pk_add_f16 v144, v130, v144
    v_pk_add_f16 v145, v131, v145
    ds_read_b32 v138, v125 offset:27040
    ds_read_b32 v139, v125 offset:27092
    ds_read_b32 v140, v126 offset:27040
    ds_read_b32 v141, v126 offset:27092
    ds_write_b32 v127, v144 offset:9792
    ds_write_b32 v127, v145 offset:10192
    s_waitcnt lgkmcnt(8)
    v_perm_b32 v142, v137, v136, v128
    v_perm_b32 v143, v137, v136, v129
    v_pk_add_f16 v142, v134, v142
    v_pk_add_f16 v143, v135, v143
    ds_write_b32 v127, v142 offset:13056
    ds_write_b32 v127, v143 offset:13456
    s_waitcnt lgkmcnt(4)
    v_perm_b32 v144, v141, v140, v128
    v_perm_b32 v145, v141, v140, v129
    v_pk_add_f16 v144, v138, v144
    v_pk_add_f16 v145, v139, v145
    ds_write_b32 v127, v144 offset:16320
    ds_write_b32 v127, v145 offset:16720
    s_waitcnt lgkmcnt(0)
    s_mov_b64 exec, 1
    ds_add_u32 v165, v166 offset:4
    s_mov_b64 exec, -1
    s_add_u32 m0, s45, 0
    s_nop 0
    buffer_load_dwordx4 v100, s[8:11], 0 offen lds
    s_add_u32 m0, s45, 2048
    s_nop 0
    buffer_load_dwordx4 v101, s[8:11], 0 offen lds
    s_add_u32 m0, s45, 4096
    s_nop 0
    buffer_load_dwordx4 v102, s[8:11], 0 offen lds
    s_add_u32 m0, s45, 6144
    s_nop 0
    buffer_load_dwordx4 v103, s[8:11], 0 offen lds
    s_add_u32 m0, s45, 16384
    s_nop 0
    buffer_load_dwordx4 v104, s[8:11], 0 offen lds
    s_add_u32 m0, s45, 18432
    s_nop 0
    buffer_load_dwordx4 v105, s[8:11], 0 offen lds
    s_add_u32 m0, s45, 20480
    s_nop 0
    buffer_load_dwordx4 v106, s[8:11], 0 offen lds
    s_add_u32 m0, s45, 22528
    s_nop 0
    buffer_load_dwordx4 v107, s[8:11], 0 offen lds
    s_add_u32 m0, s44, 32768
    s_nop 0
    buffer_load_dwordx4 v108, s[8:11], 0 offen lds
    s_add_u32 m0, s44, 34816
    s_nop 0
    buffer_load_dwordx4 v109, s[8:11], 0 offen lds
    ds_read_b128 v[16:19], v117 offset:0
    ds_read_b128 v[32:35], v117 offset:0
    ds_read_b128 v[48:51], v117 offset:128
    ds_read_b128 v[20:23], v117 offset:32
    ds_read_b128 v[36:39], v117 offset:32
    ds_read_b128 v[52:55], v117 offset:160
    ds_read_b128 v[24:27], v117 offset:64
    ds_read_b128 v[40:43], v117 offset:64
    ds_read_b128 v[56:59], v117 offset:192
    ds_read_b128 v[28:31], v117 offset:96
    ds_read_b128 v[44:47], v117 offset:96
    ds_read_b128 v[60:63], v117 offset:224
    s_branch L_wf18
L_wf17:
    s_sleep 2
L_wf18:
    ds_read_b32 v167, v165 offset:48
    s_waitcnt lgkmcnt(0)
    v_readfirstlane_b32 s40, v167
    s_cmp_lt_u32 s40, 4
    s_cbranch_scc1 L_wf17
    s_add_u32 m0, s58, 0
    s_mov_b32 s41, 0
    buffer_load_dwordx4 v112, s[48:51], s41 offen lds
    s_add_u32 m0, s58, 1024
    s_mov_b32 s41, 13312
    buffer_load_dwordx4 v112, s[48:51], s41 offen lds
    s_add_u32 m0, s58, 2048
    s_mov_b32 s41, 26624
    buffer_load_dwordx4 v112, s[48:51], s41 offen lds
    s_add_u32 m0, s58, 3072
    s_mov_b32 s41, 39936
    buffer_load_dwordx4 v112, s[48:51], s41 offen lds
    s_add_u32 m0, s58, 4096
    s_mov_b32 s41, 53248
    buffer_load_dwordx4 v112, s[48:51], s41 offen lds
    s_waitcnt vmcnt(5)
    s_waitcnt lgkmcnt(0)
    s_mov_b64 exec, 1
    ds_add_u32 v165, v166 offset:20
    s_mov_b64 exec, -1
    s_cmp_gt_u32 s46, 12
    s_cbranch_scc1 L_nodnn
    s_branch L_wf20
L_wf19:
    s_sleep 1
L_wf20:
    ds_read_b32 v167, v165 offset:20
    s_waitcnt lgkmcnt(0)
    v_readfirstlane_b32 s40, v167
    s_cmp_lt_u32 s40, 4
    s_cbranch_scc1 L_wf19
    s_setprio 3
    s_waitcnt vmcnt(4)
    ds_read_b64_tr_b16 v[64:65], v113 offset:0
    ds_read_b64_tr_b16 v[66:67], v113 offset:256
    ds_read_b128 v[76:79], v114 offset:0
    ds_read_b128 v[80:83], v114 offset:1024
    s_waitcnt vmcnt(3)
    ds_read_b64_tr_b16 v[68:69], v113 offset:1024
    ds_read_b64_tr_b16 v[70:71], v113 offset:1280
    ds_read_b128 v[84:87], v114 offset:2048
    ds_read_b128 v[88:91], v114 offset:3072
    s_waitcnt vmcnt(2)
    ds_read_b64_tr_b16 v[72:73], v113 offset:2048
    ds_read_b64_tr_b16 v[74:75], v113 offset:2304
    ds_read_b128 v[92:95], v114 offset:4096
    ds_read_b128 v[96:99], v114 offset:5120
    s_waitcnt lgkmcnt(8)
    v_mfma_f32_32x32x16_bf16 v[16:31], v[64:67], v[76:79], v[16:31]
    v_mfma_f32_32x32x16_bf16 v[32:47], v[64:67], v[80:83], v[32:47]
    s_add_u32 m0, s58, 0
    s_mov_b32 s41, 66560
    buffer_load_dwordx4 v112, s[48:51], s41 offen lds
    s_waitcnt vmcnt(2)
    ds_read_b64_tr_b16 v[64:65], v113 offset:3072
    ds_read_b64_tr_b16 v[66:67], v113 offset:3328
    ds_read_b128 v[76:79], v114 offset:6144
    ds_read_b128 v[80:83], v114 offset:7168
    s_waitcnt lgkmcnt(8)
    v_mfma_f32_32x32x16_bf16 v[16:31], v[68:71], v[84:87], v[16:31]
    v_mfma_f32_32x32x16_bf16 v[32:47], v[68:71], v[88:91], v[32:47]
    s_add_u32 m0, s58, 1024
    s_mov_b32 s41, 79872
    buffer_load_dwordx4 v112, s[48:51], s41 offen lds
    s_waitcnt vmcnt(2)
    ds_read_b64_tr_b16 v[68:69], v113 offset:4096
    ds_read_b64_tr_b16 v[70:71], v113 offset:4352
    ds_read_b128 v[84:87], v114 offset:8192
    ds_read_b128 v[88:91], v114 offset:9216
    s_waitcnt lgkmcnt(8)
    v_mfma_f32_32x32x16_bf16 v[16:31], v[72:75], v[92:95], v[16:31]
    v_mfma_f32_32x32x16_bf16 v[32:47], v[72:75], v[96:99], v[32:47]
    s_add_u32 m0, s58, 2048
    s_mov_b32 s41, 93184
    buffer_load_dwordx4 v112, s[48:51], s41 offen lds
    s_waitcnt vmcnt(2)
    ds_read_b64_tr_b16 v[72:73], v113 offset:0
    ds_read_b64_tr_b16 v[74:75], v113 offset:256
    ds_read_b128 v[92:95], v114 offset:10240
    ds_read_b128 v[96:99], v114 offset:11264
    s_waitcnt lgkmcnt(8)
    v_mfma_f32_32x32x16_bf16 v[16:31], v[64:67], v[76:79], v[16:31]
    v_mfma_f32_32x32x16_bf16 v[32:47], v[64:67], v[80:83], v[32:47]
    s_add_u32 m0, s58, 3072
    s_mov_b32 s41, 106496
    buffer_load_dwordx4 v112, s[48:51], s41 offen lds
    s_waitcnt vmcnt(2)
    ds_read_b64_tr_b16 v[64:65], v113 offset:1024
    ds_read_b64_tr_b16 v[66:67], v113 offset:1280
    ds_read_b128 v[76:79], v114 offset:12288
    ds_read_b128 v[80:83], v114 offset:13312
    s_waitcnt lgkmcnt(8)
    v_mfma_f32_32x32x16_bf16 v[16:31], v[68:71], v[84:87], v[16:31]
    v_mfma_f32_32x32x16_bf16 v[32:47], v[68:71], v[88:91], v[32:47]
    s_add_u32 m0, s58, 4096
    s_mov_b32 s41, 119808
    buffer_load_dwordx4 v112, s[48:51], s41 offen lds
    s_waitcnt vmcnt(2)
    ds_read_b64_tr_b16 v[68:69], v113 offset:2048
    ds_read_b64_tr_b16 v[70:71], v113 offset:2304
    ds_read_b128 v[84:87], v114 offset:14336
    ds_read_b128 v[88:91], v114 offset:15360
    s_waitcnt lgkmcnt(8)
    v_mfma_f32_32x32x16_bf16 v[16:31], v[72:75], v[92:95], v[16:31]
    v_mfma_f32_32x32x16_bf16 v[32:47], v[72:75], v[96:99], v[32:47]
    s_add_u32 m0, s58, 0
    s_mov_b32 s41, 133120
    buffer_load_dwordx4 v112, s[48:51], s41 offen lds
    s_waitcnt vmcnt(2)
    ds_read_b64_tr_b16 v[72:73], v113 offset:3072
    ds_read_b64_tr_b16 v[74:75], v113 offset:3328
    ds_read_b128 v[92:95], v114 offset:16384
    ds_read_b128 v[96:99], v114 offset:17408
    s_waitcnt lgkmcnt(8)
    v_mfma_f32_32x32x16_bf16 v[16:31], v[64:67], v[76:79], v[16:31]
    v_mfma_f32_32x32x16_bf16 v[32:47], v[64:67], v[80:83], v[32:47]
    s_add_u32 m0, s58, 1024
    s_mov_b32 s41, 146432
    buffer_load_dwordx4 v112, s[48:51], s41 offen lds
    s_waitcnt vmcnt(2)
    ds_read_b64_tr_b16 v[64:65], v113 offset:4096
    ds_read_b64_tr_b16 v[66:67], v113 offset:4352
    ds_read_b128 v[76:79], v114 offset:18432
    ds_read_b128 v[80:83], v114 offset:19456
    s_waitcnt lgkmcnt(8)
    v_mfma_f32_32x32x16_bf16 v[16:31], v[68:71], v[84:87], v[16:31]
    v_mfma_f32_32x32x16_bf16 v[32:47], v[68:71], v[88:91], v[32:47]
    s_add_u32 m0, s58, 2048
    s_mov_b32 s41, 159744
    buffer_load_dwordx4 v112, s[48:51], s41 offen lds
    s_waitcnt vmcnt(2)
    ds_read_b64_tr_b16 v[68:69], v113 offset:0
    ds_read_b64_tr_b16 v[70:71], v113 offset:256
    ds_read_b128 v[84:87], v114 offset:20480
    ds_read_b128 v[88:91], v114 offset:21504
    s_waitcnt lgkmcnt(8)
    v_mfma_f32_32x32x16_bf16 v[16:31], v[72:75], v[92:95], v[16:31]
    v_mfma_f32_32x32x16_bf16 v[32:47], v[72:75], v[96:99], v[32:47]
    s_add_u32 m0, s58, 3072
    s_mov_b32 s41, 173056
    buffer_load_dwordx4 v112, s[48:51], s41 offen lds
    s_waitcnt vmcnt(2)
    ds_read_b64_tr_b16 v[72:73], v113 offset:1024
    ds_read_b64_tr_b16 v[74:75], v113 offset:1280
    ds_read_b128 v[92:95], v114 offset:22528
    ds_read_b128 v[96:99], v114 offset:23552
    s_waitcnt lgkmcnt(8)
    v_mfma_f32_32x32x16_bf16 v[16:31], v[64:67], v[76:79], v[16:31]
    v_mfma_f32_32x32x16_bf16 v[32:47], v[64:67], v[80:83], v[32:47]
    s_add_u32 m0, s58, 4096
    s_mov_b32 s41, 186368
    buffer_load_dwordx4 v112, s[48:51], s41 offen lds
    s_waitcnt vmcnt(2)
    ds_read_b64_tr_b16 v[64:65], v113 offset:2048
    ds_read_b64_tr_b16 v[66:67], v113 offset:2304
    ds_read_b128 v[76:79], v114 offset:24576
    ds_read_b128 v[80:83], v114 offset:25600
    s_waitcnt lgkmcnt(8)
    v_mfma_f32_32x32x16_bf16 v[16:31], v[68:71], v[84:87], v[16:31]
    v_mfma_f32_32x32x16_bf16 v[32:47], v[68:71], v[88:91], v[32:47]
    s_add_u32 m0, s58, 0
    s_mov_b32 s41, 199680
    buffer_load_dwordx4 v112, s[48:51], s41 offen lds
    s_waitcnt vmcnt(2)
    ds_read_b64_tr_b16 v[68:69], v113 offset:3072
    ds_read_b64_tr_b16 v[70:71], v113 offset:3328
    ds_read_b128 v[84:87], v114 offset:26624
    ds_read_b128 v[88:91], v114 offset:27648
    s_waitcnt lgkmcnt(8)
    v_mfma_f32_32x32x16_bf16 v[16:31], v[72:75], v[92:95], v[16:31]
    v_mfma_f32_32x32x16_bf16 v[32:47], v[72:75], v[96:99], v[32:47]
    s_add_u32 m0, s58, 1024
    s_mov_b32 s41, 212992
    buffer_load_dwordx4 v112, s[48:51], s41 offen lds
    s_waitcnt vmcnt(2)
    ds_read_b64_tr_b16 v[72:73], v113 offset:4096
    ds_read_b64_tr_b16 v[74:75], v113 offset:4352
    ds_read_b128 v[92:95], v114 offset:28672
    ds_read_b128 v[96:99], v114 offset:29696
    s_waitcnt lgkmcnt(8)
    v_mfma_f32_32x32x16_bf16 v[16:31], v[64:67], v[76:79], v[16:31]
    v_mfma_f32_32x32x16_bf16 v[32:47], v[64:67], v[80:83], v[32:47]
    s_add_u32 m0, s58, 2048
    s_mov_b32 s41, 226304
    buffer_load_dwordx4 v112, s[48:51], s41 offen lds
    s_waitcnt vmcnt(2)
    ds_read_b64_tr_b16 v[64:65], v113 offset:0
    ds_read_b64_tr_b16 v[66:67], v113 offset:256
    ds_read_b128 v[76:79], v114 offset:30720
    ds_read_b128 v[80:83], v114 offset:31744
    s_waitcnt lgkmcnt(8)
    v_mfma_f32_32x32x16_bf16 v[16:31], v[68:71], v[84:87], v[16:31]
    v_mfma_f32_32x32x16_bf16 v[32:47], v[68:71], v[88:91], v[32:47]
    s_add_u32 m0, s58, 3072
    s_mov_b32 s41, 239616
    buffer_load_dwordx4 v112, s[48:51], s41 offen lds
    s_waitcnt vmcnt(2)
    ds_read_b64_tr_b16 v[68:69], v113 offset:1024
    ds_read_b64_tr_b16 v[70:71], v113 offset:1280
    ds_read_b128 v[84:87], v114 offset:32768
    ds_read_b128 v[88:91], v114 offset:33792
    s_waitcnt lgkmcnt(8)
    v_mfma_f32_32x32x16_bf16 v[16:31], v[72:75], v[92:95], v[16:31]
    v_mfma_f32_32x32x16_bf16 v[32:47], v[72:75], v[96:99], v[32:47]
    s_add_u32 m0, s58, 4096
    s_mov_b32 s41, 252928
    buffer_load_dwordx4 v112, s[48:51], s41 offen lds
    s_waitcnt vmcnt(2)
    ds_read_b64_tr_b16 v[72:73], v113 offset:2048
    ds_read_b64_tr_b16 v[74:75], v113 offset:2304
    ds_read_b128 v[92:95], v114 offset:34816
    ds_read_b128 v[96:99], v114 offset:35840
    s_waitcnt lgkmcnt(8)
    v_mfma_f32_32x32x16_bf16 v[16:31], v[64:67], v[76:79], v[16:31]
    v_mfma_f32_32x32x16_bf16 v[32:47], v[64:67], v[80:83], v[32:47]
    s_add_u32 m0, s58, 0
    s_mov_b32 s41, 266240
    buffer_load_dwordx4 v112, s[48:51], s41 offen lds
    s_waitcnt vmcnt(2)
    ds_read_b64_tr_b16 v[64:65], v113 offset:3072
    ds_read_b64_tr_b16 v[66:67], v113 offset:3328
    ds_read_b128 v[76:79], v114 offset:36864
    ds_read_b128 v[80:83], v114 offset:37888
    s_waitcnt lgkmcnt(8)
    v_mfma_f32_32x32x16_bf16 v[16:31], v[68:71], v[84:87], v[16:31]
    v_mfma_f32_32x32x16_bf16 v[32:47], v[68:71], v[88:91], v[32:47]
    s_add_u32 m0, s58, 1024
    s_mov_b32 s41, 279552
    buffer_load_dwordx4 v112, s[48:51], s41 offen lds
    s_waitcnt vmcnt(2)
    ds_read_b64_tr_b16 v[68:69], v113 offset:4096
    ds_read_b64_tr_b16 v[70:71], v113 offset:4352
    ds_read_b128 v[84:87], v114 offset:38912
    ds_read_b128 v[88:91], v114 offset:39936
    s_waitcnt lgkmcnt(8)
    v_mfma_f32_32x32x16_bf16 v[16:31], v[72:75], v[92:95], v[16:31]
    v_mfma_f32_32x32x16_bf16 v[32:47], v[72:75], v[96:99], v[32:47]
    s_add_u32 m0, s58, 2048
    s_mov_b32 s41, 292864
    buffer_load_dwordx4 v112, s[48:51], s41 offen lds
    s_branch L_wf22
L_wf21:
    s_sleep 1
L_wf22:
    ds_read_b32 v167, v165 offset:52
    s_waitcnt lgkmcnt(0)
    v_readfirstlane_b32 s40, v167
    s_cmp_lt_u32 s40, 4
    s_cbranch_scc1 L_wf21
    s_waitcnt vmcnt(2)
    ds_read_b64_tr_b16 v[72:73], v113 offset:0
    ds_read_b64_tr_b16 v[74:75], v113 offset:256
    ds_read_b128 v[92:95], v110 offset:0
    ds_read_b128 v[96:99], v110 offset:1024
    v_mfma_f32_32x32x16_bf16 v[16:31], v[64:67], v[76:79], v[16:31]
    v_mfma_f32_32x32x16_bf16 v[32:47], v[64:67], v[80:83], v[32:47]
    s_add_u32 m0, s58, 3072
    s_mov_b32 s41, 306176
    buffer_load_dwordx4 v112, s[48:51], s41 offen lds
    s_waitcnt vmcnt(2)
    ds_read_b64_tr_b16 v[64:65], v113 offset:1024
    ds_read_b64_tr_b16 v[66:67], v113 offset:1280
    ds_read_b128 v[76:79], v110 offset:2048
    ds_read_b128 v[80:83], v110 offset:3072
    v_mfma_f32_32x32x16_bf16 v[16:31], v[68:71], v[84:87], v[16:31]
    v_mfma_f32_32x32x16_bf16 v[32:47], v[68:71], v[88:91], v[32:47]
    s_add_u32 m0, s58, 4096
    s_mov_b32 s41, 319488
    buffer_load_dwordx4 v112, s[48:51], s41 offen lds
    s_waitcnt vmcnt(2)
    ds_read_b64_tr_b16 v[68:69], v113 offset:2048
    ds_read_b64_tr_b16 v[70:71], v113 offset:2304
    ds_read_b128 v[84:87], v110 offset:4096
    ds_read_b128 v[88:91], v110 offset:5120
    s_waitcnt lgkmcnt(8)
    v_mfma_f32_32x32x16_bf16 v[16:31], v[72:75], v[92:95], v[16:31]
    v_mfma_f32_32x32x16_bf16 v[32:47], v[72:75], v[96:99], v[32:47]
    s_add_u32 m0, s58, 0
    s_mov_b32 s41, 332800
    buffer_load_dwordx4 v112, s[48:51], s41 offen lds
    s_waitcnt vmcnt(2)
    ds_read_b64_tr_b16 v[72:73], v113 offset:3072
    ds_read_b64_tr_b16 v[74:75], v113 offset:3328
    ds_read_b128 v[92:95], v110 offset:6144
    ds_read_b128 v[96:99], v110 offset:7168
    s_waitcnt lgkmcnt(8)
    v_mfma_f32_32x32x16_bf16 v[16:31], v[64:67], v[76:79], v[16:31]
    v_mfma_f32_32x32x16_bf16 v[32:47], v[64:67], v[80:83], v[32:47]
    s_waitcnt vmcnt(1)
    ds_read_b64_tr_b16 v[64:65], v113 offset:4096
    ds_read_b64_tr_b16 v[66:67], v113 offset:4352
    ds_read_b128 v[76:79], v110 offset:8192
    ds_read_b128 v[80:83], v110 offset:9216
    s_waitcnt lgkmcnt(8)
    v_mfma_f32_32x32x16_bf16 v[16:31], v[68:71], v[84:87], v[16:31]
    v_mfma_f32_32x32x16_bf16 v[32:47], v[68:71], v[88:91], v[32:47]
    s_waitcnt vmcnt(0)
    ds_read_b64_tr_b16 v[68:69], v113 offset:0
    ds_read_b64_tr_b16 v[70:71], v113 offset:256
    ds_read_b128 v[84:87], v110 offset:10240
    ds_read_b128 v[88:91], v110 offset:11264
    s_waitcnt lgkmcnt(8)
    v_mfma_f32_32x32x16_bf16 v[16:31], v[72:75], v[92:95], v[16:31]
    v_mfma_f32_32x32x16_bf16 v[32:47], v[72:75], v[96:99], v[32:47]
    s_waitcnt lgkmcnt(4)
    v_mfma_f32_32x32x16_bf16 v[16:31], v[64:67], v[76:79], v[16:31]
    v_mfma_f32_32x32x16_bf16 v[32:47], v[64:67], v[80:83], v[32:47]
    s_waitcnt lgkmcnt(0)
    v_mfma_f32_32x32x16_bf16 v[16:31], v[68:71], v[84:87], v[16:31]
    v_mfma_f32_32x32x16_bf16 v[32:47], v[68:71], v[88:91], v[32:47]
    s_setprio 0
    s_waitcnt lgkmcnt(0)
    s_mov_b64 exec, 1
    ds_add_u32 v165, v166 offset:24
    s_mov_b64 exec, -1
    s_mov_b32 s40, 0xbdd2d3e8
    v_mov_b32 v9, 0xc0135761
    s_nop 6
    v_mul_f32 v2, v16, v16
    v_mul_f32 v3, v17, v17
    v_mul_f32 v4, v18, v18
    v_mul_f32 v5, v19, v19
    v_fma_f32 v2, v2, s40, v9
    v_fma_f32 v3, v3, s40, v9
    v_fma_f32 v4, v4, s40, v9
    v_fma_f32 v5, v5, s40, v9
    v_mul_f32 v2, v16, v2
    v_mul_f32 v3, v17, v3
    v_mul_f32 v4, v18, v4
    v_mul_f32 v5, v19, v5
    v_exp_f32 v2, v2
    v_exp_f32 v3, v3
    v_exp_f32 v4, v4
    v_exp_f32 v5, v5
    v_add_f32 v2, 1.0, v2
    v_add_f32 v3, 1.0, v3
    v_add_f32 v4, 1.0, v4
    v_add_f32 v5, 1.0, v5
    v_rcp_f32 v2, v2
    v_rcp_f32 v3, v3
    v_rcp_f32 v4, v4
    v_rcp_f32 v5, v5
    v_mul_f32 v16, v16, v48
    v_mul_f32 v17, v17, v49
    v_mul_f32 v18, v18, v50
    v_mul_f32 v19, v19, v51
    v_fmac_f32 v118, v16, v2
    v_fmac_f32 v118, v17, v3
    v_fmac_f32 v118, v18, v4
    v_fmac_f32 v118, v19, v5
    v_mul_f32 v2, v20, v20
    v_mul_f32 v3, v21, v21
    v_mul_f32 v4, v22, v22
    v_mul_f32 v5, v23, v23
    v_fma_f32 v2, v2, s40, v9
    v_fma_f32 v3, v3, s40, v9
    v_fma_f32 v4, v4, s40, v9
    v_fma_f32 v5, v5, s40, v9
    v_mul_f32 v2, v20, v2
    v_mul_f32 v3, v21, v3
    v_mul_f32 v4, v22, v4
    v_mul_f32 v5, v23, v5
    v_exp_f32 v2, v2
    v_exp_f32 v3, v3
    v_exp_f32 v4, v4
    v_exp_f32 v5, v5
    v_add_f32 v2, 1.0, v2
    v_add_f32 v3, 1.0, v3
    v_add_f32 v4, 1.0, v4
    v_add_f32 v5, 1.0, v5
    v_rcp_f32 v2, v2
    v_rcp_f32 v3, v3
    v_rcp_f32 v4, v4
    v_rcp_f32 v5, v5
    v_mul_f32 v20, v20, v52
    v_mul_f32 v21, v21, v53
    v_mul_f32 v22, v22, v54
    v_mul_f32 v23, v23, v55
    v_fmac_f32 v118, v20, v2
    v_fmac_f32 v118, v21, v3
    v_fmac_f32 v118, v22, v4
    v_fmac_f32 v118, v23, v5
    v_mul_f32 v2, v24, v24
    v_mul_f32 v3, v25, v25
    v_mul_f32 v4, v26, v26
    v_mul_f32 v5, v27, v27
    v_fma_f32 v2, v2, s40, v9
    v_fma_f32 v3, v3, s40, v9
    v_fma_f32 v4, v4, s40, v9
    v_fma_f32 v5, v5, s40, v9
    v_mul_f32 v2, v24, v2
    v_mul_f32 v3, v25, v3
    v_mul_f32 v4, v26, v4
    v_mul_f32 v5, v27, v5
    v_exp_f32 v2, v2
    v_exp_f32 v3, v3
    v_exp_f32 v4, v4
    v_exp_f32 v5, v5
    v_add_f32 v2, 1.0, v2
    v_add_f32 v3, 1.0, v3
    v_add_f32 v4, 1.0, v4
    v_add_f32 v5, 1.0, v5
    v_rcp_f32 v2, v2
    v_rcp_f32 v3, v3
    v_rcp_f32 v4, v4
    v_rcp_f32 v5, v5
    v_mul_f32 v24, v24, v56
    v_mul_f32 v25, v25, v57
    v_mul_f32 v26, v26, v58
    v_mul_f32 v27, v27, v59
    v_fmac_f32 v118, v24, v2
    v_fmac_f32 v118, v25, v3
    v_fmac_f32 v118, v26, v4
    v_fmac_f32 v118, v27, v5
    v_mul_f32 v2, v28, v28
    v_mul_f32 v3, v29, v29
    v_mul_f32 v4, v30, v30
    v_mul_f32 v5, v31, v31
    v_fma_f32 v2, v2, s40, v9
    v_fma_f32 v3, v3, s40, v9
    v_fma_f32 v4, v4, s40, v9
    v_fma_f32 v5, v5, s40, v9
    v_mul_f32 v2, v28, v2
    v_mul_f32 v3, v29, v3
    v_mul_f32 v4, v30, v4
    v_mul_f32 v5, v31, v5
    v_exp_f32 v2, v2
    v_exp_f32 v3, v3
    v_exp_f32 v4, v4
    v_exp_f32 v5, v5
    v_add_f32 v2, 1.0, v2
    v_add_f32 v3, 1.0, v3
    v_add_f32 v4, 1.0, v4
    v_add_f32 v5, 1.0, v5
    v_rcp_f32 v2, v2
    v_rcp_f32 v3, v3
    v_rcp_f32 v4, v4
    v_rcp_f32 v5, v5
    v_mul_f32 v28, v28, v60
    v_mul_f32 v29, v29, v61
    v_mul_f32 v30, v30, v62
    v_mul_f32 v31, v31, v63
    v_fmac_f32 v118, v28, v2
    v_fmac_f32 v118, v29, v3
    v_fmac_f32 v118, v30, v4
    v_fmac_f32 v118, v31, v5
    v_mul_f32 v2, v32, v32
    v_mul_f32 v3, v33, v33
    v_mul_f32 v4, v34, v34
    v_mul_f32 v5, v35, v35
    v_fma_f32 v2, v2, s40, v9
    v_fma_f32 v3, v3, s40, v9
    v_fma_f32 v4, v4, s40, v9
    v_fma_f32 v5, v5, s40, v9
    v_mul_f32 v2, v32, v2
    v_mul_f32 v3, v33, v3
    v_mul_f32 v4, v34, v4
    v_mul_f32 v5, v35, v5
    v_exp_f32 v2, v2
    v_exp_f32 v3, v3
    v_exp_f32 v4, v4
    v_exp_f32 v5, v5
    v_add_f32 v2, 1.0, v2
    v_add_f32 v3, 1.0, v3
    v_add_f32 v4, 1.0, v4
    v_add_f32 v5, 1.0, v5
    v_rcp_f32 v2, v2
    v_rcp_f32 v3, v3
    v_rcp_f32 v4, v4
    v_rcp_f32 v5, v5
    v_mul_f32 v32, v32, v48
    v_mul_f32 v33, v33, v49
    v_mul_f32 v34, v34, v50
    v_mul_f32 v35, v35, v51
    v_fmac_f32 v119, v32, v2
    v_fmac_f32 v119, v33, v3
    v_fmac_f32 v119, v34, v4
    v_fmac_f32 v119, v35, v5
    v_mul_f32 v2, v36, v36
    v_mul_f32 v3, v37, v37
    v_mul_f32 v4, v38, v38
    v_mul_f32 v5, v39, v39
    v_fma_f32 v2, v2, s40, v9
    v_fma_f32 v3, v3, s40, v9
    v_fma_f32 v4, v4, s40, v9
    v_fma_f32 v5, v5, s40, v9
    v_mul_f32 v2, v36, v2
    v_mul_f32 v3, v37, v3
    v_mul_f32 v4, v38, v4
    v_mul_f32 v5, v39, v5
    v_exp_f32 v2, v2
    v_exp_f32 v3, v3
    v_exp_f32 v4, v4
    v_exp_f32 v5, v5
    v_add_f32 v2, 1.0, v2
    v_add_f32 v3, 1.0, v3
    v_add_f32 v4, 1.0, v4
    v_add_f32 v5, 1.0, v5
    v_rcp_f32 v2, v2
    v_rcp_f32 v3, v3
    v_rcp_f32 v4, v4
    v_rcp_f32 v5, v5
    v_mul_f32 v36, v36, v52
    v_mul_f32 v37, v37, v53
    v_mul_f32 v38, v38, v54
    v_mul_f32 v39, v39, v55
    v_fmac_f32 v119, v36, v2
    v_fmac_f32 v119, v37, v3
    v_fmac_f32 v119, v38, v4
    v_fmac_f32 v119, v39, v5
    v_mul_f32 v2, v40, v40
    v_mul_f32 v3, v41, v41
    v_mul_f32 v4, v42, v42
    v_mul_f32 v5, v43, v43
    v_fma_f32 v2, v2, s40, v9
    v_fma_f32 v3, v3, s40, v9
    v_fma_f32 v4, v4, s40, v9
    v_fma_f32 v5, v5, s40, v9
    v_mul_f32 v2, v40, v2
    v_mul_f32 v3, v41, v3
    v_mul_f32 v4, v42, v4
    v_mul_f32 v5, v43, v5
    v_exp_f32 v2, v2
    v_exp_f32 v3, v3
    v_exp_f32 v4, v4
    v_exp_f32 v5, v5
    v_add_f32 v2, 1.0, v2
    v_add_f32 v3, 1.0, v3
    v_add_f32 v4, 1.0, v4
    v_add_f32 v5, 1.0, v5
    v_rcp_f32 v2, v2
    v_rcp_f32 v3, v3
    v_rcp_f32 v4, v4
    v_rcp_f32 v5, v5
    v_mul_f32 v40, v40, v56
    v_mul_f32 v41, v41, v57
    v_mul_f32 v42, v42, v58
    v_mul_f32 v43, v43, v59
    v_fmac_f32 v119, v40, v2
    v_fmac_f32 v119, v41, v3
    v_fmac_f32 v119, v42, v4
    v_fmac_f32 v119, v43, v5
    v_mul_f32 v2, v44, v44
    v_mul_f32 v3, v45, v45
    v_mul_f32 v4, v46, v46
    v_mul_f32 v5, v47, v47
    v_fma_f32 v2, v2, s40, v9
    v_fma_f32 v3, v3, s40, v9
    v_fma_f32 v4, v4, s40, v9
    v_fma_f32 v5, v5, s40, v9
    v_mul_f32 v2, v44, v2
    v_mul_f32 v3, v45, v3
    v_mul_f32 v4, v46, v4
    v_mul_f32 v5, v47, v5
    v_exp_f32 v2, v2
    v_exp_f32 v3, v3
    v_exp_f32 v4, v4
    v_exp_f32 v5, v5
    v_add_f32 v2, 1.0, v2
    v_add_f32 v3, 1.0, v3
    v_add_f32 v4, 1.0, v4
    v_add_f32 v5, 1.0, v5
    v_rcp_f32 v2, v2
    v_rcp_f32 v3, v3
    v_rcp_f32 v4, v4
    v_rcp_f32 v5, v5
    v_mul_f32 v44, v44, v60
    v_mul_f32 v45, v45, v61
    v_mul_f32 v46, v46, v62
    v_mul_f32 v47, v47, v63
    v_fmac_f32 v119, v44, v2
    v_fmac_f32 v119, v45, v3
    v_fmac_f32 v119, v46, v4
    v_fmac_f32 v119, v47, v5
    s_branch L_dnndone
L_nodnn:
    s_waitcnt vmcnt(0)
    s_waitcnt lgkmcnt(0)
    s_mov_b64 exec, 1
    ds_add_u32 v165, v166 offset:24
    s_mov_b64 exec, -1
L_dnndone:
    s_nop 1
    v_permlane32_swap_b32 v118, v119
    s_nop 1
    v_add_f32 v118, v118, v119
    ds_write_b32 v116, v118
    s_waitcnt lgkmcnt(0)
    s_mov_b64 exec, 1
    ds_add_u32 v165, v166 offset:40
    s_mov_b64 exec, -1
    s_cmp_eq_u32 s47, 3
    s_cbranch_scc1 L_fin
    s_endpgm
L_fin:
    v_lshlrev_b32 v2, 2, v1
    v_add_u32 v3, 162112, v2
    s_lshl_b32 s41, s59, 8
    v_add_u32 v2, s41, v2
    v_mov_b32 v10, 0
    global_load_ushort v11, v10, s[30:31]
    s_branch L_wf24
L_wf23:
    s_sleep 4
L_wf24:
    ds_read_b32 v167, v165 offset:40
    s_waitcnt lgkmcnt(0)
    v_readfirstlane_b32 s40, v167
    s_cmp_lt_u32 s40, 4
    s_cbranch_scc1 L_wf23
    ds_read2st64_b32 v[4:5], v3 offset0:0 offset1:1
    ds_read2st64_b32 v[6:7], v3 offset0:2 offset1:3
    s_waitcnt lgkmcnt(0)
    v_add_f32 v4, v4, v5
    v_add_f32 v6, v6, v7
    v_add_f32 v4, v4, v6
    global_store_dword v2, v4, s[36:37] sc1
    v_mov_b32 v5, s59
    s_waitcnt vmcnt(0)
    s_mov_b64 exec, 1
    global_store_byte v5, v166, s[34:35] sc1
    s_mov_b64 exec, -1
    v_lshlrev_b32 v2, 2, v1
    s_lshl_b32 s41, s56, 10
    v_add_u32 v3, s41, v2
    s_lshl_b32 s41, s56, 8
    s_add_u32 s41, s41, 0x10000
    v_add_u32 v4, s41, v2
    v_and_b32 v6, 15, v1
    v_lshlrev_b32 v6, 3, v6
    v_add_u32 v6, 163136, v6
    s_lshl_b32 s41, s56, 7
    v_lshl_add_u32 v10, v1, 1, s41
    s_lshl_b32 s41, s56, 2
    v_mov_b32 v7, s41
    s_lshl_b32 s41, s57, 4
    s_lshl_b64 s[42:43], 0xffff, s41
    v_mov_b32 v20, 0
    s_branch L_wf26
L_wf25:
    s_sleep 8
L_wf26:
    ds_read_b32 v167, v165 offset:16
    s_waitcnt lgkmcnt(0)
    v_readfirstlane_b32 s40, v167
    s_cmp_lt_u32 s40, 16
    s_cbranch_scc1 L_wf25
    s_waitcnt vmcnt(0)
    s_branch L_poll1
L_poll:
    s_sleep 8
L_poll1:
    global_load_dword v8, v7, s[34:35] sc1
    ds_read_b32 v167, v165 offset:44
    s_waitcnt vmcnt(0) lgkmcnt(0)
    v_readfirstlane_b32 s44, v8
    v_readfirstlane_b32 s41, v167
    s_and_b32 s40, s44, 0x01010101
    s_cmp_eq_u32 s40, 0x01010101
    s_cbranch_scc1 L_all
    s_cmp_lt_u32 s41, 4
    s_cbranch_scc1 L_poll
    ds_read_b64 v[8:9], v6
    v_mov_b32 v21, 3
    s_waitcnt lgkmcnt(0)
    v_add_f32 v8, v8, v9
    s_mov_b64 exec, s[42:43]
    global_store_dword v4, v8, s[36:37] sc1
    s_waitcnt vmcnt(0)
    s_mov_b64 exec, 1
    global_store_byte v5, v21, s[34:35] sc1
    s_mov_b64 exec, -1
    s_waitcnt vmcnt(0)
    global_load_dword v8, v7, s[34:35] sc1
    s_waitcnt vmcnt(0)
    v_readfirstlane_b32 s44, v8
    s_and_b32 s40, s44, 0x01010101
    s_cmp_eq_u32 s40, 0x01010101
    s_cbranch_scc1 L_all
    s_endpgm
L_all:
    global_load_dword v16, v3, s[36:37] offset:0 sc1
    global_load_dword v17, v3, s[36:37] offset:256 sc1
    global_load_dword v18, v3, s[36:37] offset:512 sc1
    global_load_dword v19, v3, s[36:37] offset:768 sc1
    s_mov_b64 s[46:47], s[42:43]
    s_and_b32 s40, s44, 0x02020202
    s_cmp_eq_u32 s40, 0
    s_cbranch_scc1 L_noother
    global_load_dword v20, v4, s[36:37] sc1
    s_bitcmp1_b32 s44, 1
    s_cselect_b32 s40, 0xffff, 0
    s_or_b32 s46, s46, s40
    s_bitcmp1_b32 s44, 9
    s_cselect_b32 s40, 0xffff0000, 0
    s_or_b32 s46, s46, s40
    s_bitcmp1_b32 s44, 17
    s_cselect_b32 s40, 0xffff, 0
    s_or_b32 s47, s47, s40
    s_bitcmp1_b32 s44, 25
    s_cselect_b32 s40, 0xffff0000, 0
    s_or_b32 s47, s47, s40
L_noother:
    s_waitcnt vmcnt(0)
    v_lshlrev_b32 v11, 16, v11
    v_add_f32 v16, v16, v17
    v_add_f32 v18, v18, v19
    v_add_f32 v16, v16, v18
    v_add_f32 v11, v11, v16
    s_setprio 3
    s_branch L_wf28
L_wf27:
    s_sleep 1
L_wf28:
    ds_read_b32 v167, v165 offset:44
    s_waitcnt lgkmcnt(0)
    v_readfirstlane_b32 s40, v167
    s_cmp_lt_u32 s40, 4
    s_cbranch_scc1 L_wf27
    ds_read_b64 v[8:9], v6
    s_waitcnt lgkmcnt(0)
    v_add_f32 v8, v8, v9
    v_cndmask_b32 v8, v20, v8, s[42:43]
    v_add_f32 v11, v11, v8
    v_cvt_pk_bf16_f32 v11, v11, 0
    s_mov_b64 exec, s[46:47]
    global_store_short v10, v11, s[32:33]
    s_mov_b64 exec, -1
    s_endpgm
L_H2:
    s_setprio 1
    global_load_dword v105, v2, s[38:39]
    v_min_u32 v57, 233, v0
    v_mul_u32_u24 v58, 841, v57
    v_lshrrev_b32 v58, 16, v58
    v_mul_u32_u24 v59, 78, v58
    v_sub_u32 v59, v57, v59
    v_mul_u32_u24 v2, 1352, v58
    v_lshl_add_u32 v2, v59, 4, v2
    v_mul_u32_u24 v4, 1424, v58
    v_lshl_add_u32 v4, v59, 4, v4
    v_mov_b32 v60, 0x40000000
    v_cmp_eq_u32 vcc, 2, v58
    v_lshrrev_b32 v57, 3, v0
    v_min_u32 v57, 26, v57
    v_cndmask_b32 v3, v2, v60, vcc
    v_bfe_u32 v58, v0, 2, 1
    v_and_b32 v59, 3, v0
    v_mul_u32_u24 v5, 1352, v57
    v_mul_u32_u24 v61, 52, v58
    v_add_u32 v5, v5, v61
    v_lshl_add_u32 v5, v59, 4, v5
    v_add_u32 v5, 1248, v5
    v_cmp_eq_u32 vcc, 26, v57
    v_mul_u32_u24 v7, 1424, v57
    v_mul_u32_u24 v61, 80, v58
    v_cndmask_b32 v5, v5, v60, vcc
    v_add_u32 v7, v7, v61
    v_add_u32 v7, 1248, v7
    v_lshl_add_u32 v6, v59, 4, v7
    v_add_u32 v7, 64, v7
    v_cmp_eq_u32 vcc, 3, v59
    v_mov_b32 v61, -1
    v_mov_b32 v12, 0
    v_mov_b32 v13, 0
    v_mov_b32 v14, 0
    v_mov_b32 v15, 0
    v_cndmask_b32 v8, v61, v12, vcc
    v_add_u32 v4, 121104, v4
    v_add_u32 v6, 121104, v6
    v_add_u32 v7, 121104, v7
    s_waitcnt vmcnt(4)
    v_lshlrev_b32 v56, 16, v148
    v_and_b32 v57, 0xffff0000, v148
    v_cvt_pk_f16_f32 v148, v56, v57
    v_lshlrev_b32 v58, 16, v149
    v_and_b32 v59, 0xffff0000, v149
    v_cvt_pk_f16_f32 v149, v58, v59
    v_lshlrev_b32 v56, 16, v150
    v_and_b32 v57, 0xffff0000, v150
    v_cvt_pk_f16_f32 v150, v56, v57
    v_lshlrev_b32 v58, 16, v151
    v_and_b32 v59, 0xffff0000, v151
    v_cvt_pk_f16_f32 v151, v58, v59
    ds_write_b128 v160, v[148:151] offset:0
    s_waitcnt vmcnt(3)
    v_lshlrev_b32 v56, 16, v152
    v_and_b32 v57, 0xffff0000, v152
    v_cvt_pk_f16_f32 v152, v56, v57
    v_lshlrev_b32 v58, 16, v153
    v_and_b32 v59, 0xffff0000, v153
    v_cvt_pk_f16_f32 v153, v58, v59
    v_lshlrev_b32 v56, 16, v154
    v_and_b32 v57, 0xffff0000, v154
    v_cvt_pk_f16_f32 v154, v56, v57
    v_lshlrev_b32 v58, 16, v155
    v_and_b32 v59, 0xffff0000, v155
    v_cvt_pk_f16_f32 v155, v58, v59
    v_max3_f32 v56, abs(v56), abs(v57), abs(v58)
    v_cmp_le_f32 vcc, 0x3a800000, v56
    s_cbranch_vccnz L_wok29
    s_mov_b64 exec, 1
    ds_add_u32 v165, v166 offset:56
    s_mov_b64 exec, -1
L_wok29:
    ds_write_b128 v160, v[152:155] offset:12288
    s_waitcnt vmcnt(2)
    v_lshlrev_b32 v56, 16, v156
    v_and_b32 v57, 0xffff0000, v156
    v_cvt_pk_f16_f32 v156, v56, v57
    v_lshlrev_b32 v58, 16, v157
    v_and_b32 v59, 0xffff0000, v157
    v_cvt_pk_f16_f32 v157, v58, v59
    v_lshlrev_b32 v56, 16, v158
    v_and_b32 v57, 0xffff0000, v158
    v_cvt_pk_f16_f32 v158, v56, v57
    v_lshlrev_b32 v58, 16, v159
    v_and_b32 v59, 0xffff0000, v159
    v_cvt_pk_f16_f32 v159, v58, v59
    ds_write_b128 v160, v[156:159] offset:24576
    s_waitcnt lgkmcnt(0)
    s_mov_b64 exec, 1
    ds_add_u32 v165, v166 offset:0
    s_mov_b64 exec, -1
    s_waitcnt vmcnt(0)
    s_waitcnt lgkmcnt(0)
    s_mov_b64 exec, 1
    ds_add_u32 v165, v166 offset:8
    s_mov_b64 exec, -1
    s_mov_b32 s41, 35152
    buffer_load_dwordx4 v[16:19], v2, s[12:15], s41 offen
    s_mov_b32 s41, 39208
    buffer_load_dwordx4 v[20:23], v2, s[12:15], s41 offen
    s_mov_b32 s41, 43264
    buffer_load_dwordx4 v[24:27], v2, s[12:15], s41 offen
    s_mov_b32 s41, 47320
    buffer_load_dwordx4 v[28:31], v2, s[12:15], s41 offen
    s_mov_b32 s41, 51376
    buffer_load_dwordx4 v[32:35], v2, s[12:15], s41 offen
    s_mov_b32 s41, 55432
    buffer_load_dwordx4 v[36:39], v2, s[12:15], s41 offen
    s_mov_b32 s41, 59488
    buffer_load_dwordx4 v[40:43], v2, s[12:15], s41 offen
    s_mov_b32 s41, 63544
    buffer_load_dwordx4 v[44:47], v2, s[12:15], s41 offen
    s_mov_b32 s41, 67600
    buffer_load_dwordx4 v[48:51], v3, s[12:15], s41 offen
    s_mov_b32 s41, 35152
    buffer_load_dwordx4 v[52:55], v5, s[12:15], s41 offen
    v_min_u32 v56, 41, v1
    v_mul_u32_u24 v57, 4682, v56
    v_lshrrev_b32 v57, 16, v57
    v_mul_u32_u24 v58, 14, v57
    v_sub_u32 v58, v56, v58
    v_cmp_lt_u32 vcc, 6, v58
    v_subrev_u32 v60, 7, v58
    v_mul_u32_u24 v62, 13, v57
    v_cndmask_b32 v59, 0, v166, vcc
    v_cndmask_b32 v60, v58, v60, vcc
    v_lshrrev_b32 v61, 1, v60
    v_lshlrev_b32 v61, 2, v61
    v_lshl_add_u32 v61, v59, 1, v61
    v_and_b32 v63, 1, v60
    v_add_u32 v61, v61, v63
    v_min_u32 v61, 12, v61
    v_add_lshl_u32 v61, v61, v62, 2
    global_load_dword v9, v61, s[22:23]
    v_mul_u32_u24 v10, 80, v59
    v_lshl_add_u32 v10, v60, 2, v10
    v_cmp_eq_u32 vcc, 1, v57
    v_mov_b32 v61, 159428
    v_mov_b32 v62, 120980
    v_cndmask_b32 v61, v61, v62, vcc
    v_add_u32 v10, v10, v61
    v_cmp_eq_u32 vcc, 6, v60
    v_add_u32 v59, 1, v59
    s_nop 0
    v_cndmask_b32 v11, 0, v59, vcc
    v_lshlrev_b32 v56, 2, v1
    buffer_load_dword v106, v56, s[52:55], 0 offen offset:208
    v_lshrrev_b32 v60, 4, v1
    v_lshlrev_b32 v60, 4, v60
    buffer_load_dwordx4 v[116:119], v60, s[52:55], 0 offen offset:260
    v_lshrrev_b32 v57, 4, v0
    v_add_u32 v58, 16, v57
    v_min_u32 v58, 25, v58
    v_lshlrev_b32 v57, 1, v57
    v_lshlrev_b32 v58, 1, v58
    global_load_ushort v107, v57, s[22:23] offset:156
    global_load_ushort v108, v58, s[22:23] offset:156
    s_and_b32 s43, s47, 1
    s_lshr_b32 s44, s47, 1
    s_lshl_b32 s40, s56, 1
    s_add_u32 s40, s40, s43
    s_mul_i32 s40, s40, 3328
    s_mul_i32 s41, s44, 12
    s_add_u32 s40, s40, s41
    v_and_b32 v56, 31, v1
    v_mul_u32_u24 v56, 104, v56
    v_add_u32 v56, s40, v56
    global_load_dwordx3 v[144:146], v56, s[16:17] offset:80
    s_mul_i32 s45, s44, 6144
    s_lshl_b32 s43, s43, 10
    s_add_u32 s45, s45, s43
    s_add_u32 s45, s45, 61440
    s_lshr_b32 s40, s2, 3
    s_mul_i32 s41, s40, 35
    s_add_u32 s41, s41, 549
    v_min_u32 v60, 34, v0
    v_add_lshl_u32 v60, v60, s41, 7
    s_mul_i32 s41, s40, 85
    v_subrev_u32 v61, 64, v0
    v_min_u32 v61, 84, v61
    v_add_lshl_u32 v61, v61, s41, 7
    s_cmp_eq_u32 s47, 0
    s_cbranch_scc1 L_pf0
    buffer_load_dword v164, v61, s[48:51], 0 offen
    s_branch L_pfd
L_pf0:
    buffer_load_dword v164, v60, s[12:15], 0 offen
L_pfd:
    v_lshrrev_b32 v56, 5, v1
    v_bfe_u32 v57, v1, 4, 1
    v_bfe_u32 v58, v1, 2, 2
    v_and_b32 v59, 3, v1
    v_lshlrev_b32 v59, 3, v59
    v_lshl_add_u32 v60, v56, 3, v58
    v_lshl_add_u32 v61, v57, 5, v59
    v_and_b32 v62, 31, v1
    v_mul_u32_u24 v89, 80, v62
    v_lshl_add_u32 v89, v56, 4, v89
    v_add_u32 v89, 159552, v89
    s_lshl_b32 s40, s47, 6
    v_add_u32 v62, s40, v62
    v_mul_u32_u24 v88, 56, v62
    v_lshl_add_u32 v88, v56, 3, v88
    s_lshl_b32 s41, s47, 7
    s_add_u32 s43, s41, 40960
    v_add_u32 v61, s43, v61
    v_mul_u32_u24 v62, 1352, v60
    v_add_u32 v85, v62, v61
    v_add_u32 v62, 16, v60
    v_min_u32 v62, 25, v62
    v_mul_u32_u24 v62, 1352, v62
    v_add_u32 v86, v62, v61
    v_add_u32 v62, 20, v60
    v_min_u32 v62, 25, v62
    v_mul_u32_u24 v62, 1352, v62
    v_add_u32 v87, v62, v61
    v_add_u32 v59, s41, v59
    v_lshrrev_b32 v60, 4, v1
    v_lshl_add_u32 v60, v60, 3, v58
    v_add_u32 v62, 0, v60
    v_min_u32 v62, 25, v62
    v_mul_u32_u24 v62, 1352, v62
    v_add_u32 v80, v62, v59
    v_add_u32 v62, 4, v60
    v_min_u32 v62, 25, v62
    v_mul_u32_u24 v62, 1352, v62
    v_add_u32 v81, v62, v59
    v_mov_b32 v59, 2480
    s_add_u32 s41, s40, 0
    v_add_u32 v56, s41, v1
    v_mul_u32_u24 v57, 2521, v56
    v_lshrrev_b32 v57, 16, v57
    v_mul_u32_u24 v58, 26, v57
    v_sub_u32 v58, v56, v58
    v_cmp_gt_u32 vcc, 676, v56
    v_mul_u32_u24 v58, 80, v58
    v_lshl_add_u32 v58, v57, 1, v58
    v_cndmask_b32 v58, v59, v58, vcc
    v_add_u32 v82, 159552, v58
    s_add_u32 s41, s40, 256
    v_add_u32 v56, s41, v1
    v_mul_u32_u24 v57, 2521, v56
    v_lshrrev_b32 v57, 16, v57
    v_mul_u32_u24 v58, 26, v57
    v_sub_u32 v58, v56, v58
    v_cmp_gt_u32 vcc, 676, v56
    v_mul_u32_u24 v58, 80, v58
    v_lshl_add_u32 v58, v57, 1, v58
    v_cndmask_b32 v58, v59, v58, vcc
    v_add_u32 v83, 159552, v58
    s_add_u32 s41, s40, 512
    v_add_u32 v56, s41, v1
    v_mul_u32_u24 v57, 2521, v56
    v_lshrrev_b32 v57, 16, v57
    v_mul_u32_u24 v58, 26, v57
    v_sub_u32 v58, v56, v58
    v_cmp_gt_u32 vcc, 676, v56
    v_mul_u32_u24 v58, 80, v58
    v_lshl_add_u32 v58, v57, 1, v58
    v_cndmask_b32 v58, v59, v58, vcc
    v_add_u32 v84, 159552, v58
    v_lshlrev_b32 v99, 4, v0
    v_lshrrev_b32 v57, 4, v0
    v_add_u32 v58, 16, v57
    v_min_u32 v58, 25, v58
    v_bfe_u32 v59, v0, 3, 1
    v_and_b32 v60, 7, v0
    v_min_u32 v61, 6, v60
    v_lshl_add_u32 v61, v61, 2, v59
    v_min_u32 v62, 5, v60
    v_lshl_add_u32 v62, v62, 2, v59
    v_mul_u32_u24 v63, 26, v57
    v_add_u32 v90, v63, v61
    v_mul_u32_u24 v90, 56, v90
    v_add_u32 v91, v63, v62
    v_mul_u32_u24 v91, 56, v91
    v_mul_u32_u24 v94, 816, v57
    v_mul_u32_u24 v63, 400, v59
    v_add_u32 v94, v94, v63
    v_lshl_add_u32 v94, v60, 2, v94
    v_add_u32 v94, 83024, v94
    v_mul_u32_u24 v63, 26, v58
    v_add_u32 v92, v63, v61
    v_mul_u32_u24 v92, 56, v92
    v_add_u32 v93, v63, v62
    v_mul_u32_u24 v93, 56, v93
    v_mul_u32_u24 v95, 816, v58
    v_mul_u32_u24 v63, 400, v59
    v_add_u32 v95, v95, v63
    v_lshl_add_u32 v95, v60, 2, v95
    v_add_u32 v95, 83024, v95
    v_mov_b32 v96, -1
    v_mov_b32 v63, 0xffff
    v_cmp_eq_u32 vcc, 6, v60
    s_nop 1
    v_cndmask_b32 v96, v96, v63, vcc
    v_cmp_eq_u32 vcc, 7, v60
    s_nop 1
    v_cndmask_b32 v96, v96, v12, vcc
    s_cmp_lg_u32 s47, 0
    s_cbranch_scc1 L_noinit
    v_lshlrev_b32 v61, 4, v1
    v_add_u32 v61, 159552, v61
    ds_write_b128 v61, v[12:15]
    ds_write_b128 v61, v[12:15] offset:1024
    ds_write_b128 v61, v[12:15] offset:1536
L_noinit:
    s_waitcnt vmcnt(16)
    v_lshlrev_b32 v56, 16, v16
    v_and_b32 v57, 0xffff0000, v16
    v_cvt_pk_f16_f32 v16, v56, v57
    v_lshlrev_b32 v58, 16, v17
    v_and_b32 v59, 0xffff0000, v17
    v_cvt_pk_f16_f32 v17, v58, v59
    v_lshlrev_b32 v56, 16, v18
    v_and_b32 v57, 0xffff0000, v18
    v_cvt_pk_f16_f32 v18, v56, v57
    v_lshlrev_b32 v58, 16, v19
    v_and_b32 v59, 0xffff0000, v19
    v_cvt_pk_f16_f32 v19, v58, v59
    s_waitcnt vmcnt(15)
    v_lshlrev_b32 v56, 16, v20
    v_and_b32 v57, 0xffff0000, v20
    v_cvt_pk_f16_f32 v20, v56, v57
    v_lshlrev_b32 v58, 16, v21
    v_and_b32 v59, 0xffff0000, v21
    v_cvt_pk_f16_f32 v21, v58, v59
    v_lshlrev_b32 v56, 16, v22
    v_and_b32 v57, 0xffff0000, v22
    v_cvt_pk_f16_f32 v22, v56, v57
    v_lshlrev_b32 v58, 16, v23
    v_and_b32 v59, 0xffff0000, v23
    v_cvt_pk_f16_f32 v23, v58, v59
    s_waitcnt vmcnt(14)
    v_lshlrev_b32 v56, 16, v24
    v_and_b32 v57, 0xffff0000, v24
    v_cvt_pk_f16_f32 v24, v56, v57
    v_lshlrev_b32 v58, 16, v25
    v_and_b32 v59, 0xffff0000, v25
    v_cvt_pk_f16_f32 v25, v58, v59
    v_lshlrev_b32 v56, 16, v26
    v_and_b32 v57, 0xffff0000, v26
    v_cvt_pk_f16_f32 v26, v56, v57
    v_lshlrev_b32 v58, 16, v27
    v_and_b32 v59, 0xffff0000, v27
    v_cvt_pk_f16_f32 v27, v58, v59
    s_waitcnt vmcnt(13)
    v_lshlrev_b32 v56, 16, v28
    v_and_b32 v57, 0xffff0000, v28
    v_cvt_pk_f16_f32 v28, v56, v57
    v_lshlrev_b32 v58, 16, v29
    v_and_b32 v59, 0xffff0000, v29
    v_cvt_pk_f16_f32 v29, v58, v59
    v_lshlrev_b32 v56, 16, v30
    v_and_b32 v57, 0xffff0000, v30
    v_cvt_pk_f16_f32 v30, v56, v57
    v_lshlrev_b32 v58, 16, v31
    v_and_b32 v59, 0xffff0000, v31
    v_cvt_pk_f16_f32 v31, v58, v59
    s_waitcnt vmcnt(12)
    v_lshlrev_b32 v56, 16, v32
    v_and_b32 v57, 0xffff0000, v32
    v_cvt_pk_f16_f32 v32, v56, v57
    v_lshlrev_b32 v58, 16, v33
    v_and_b32 v59, 0xffff0000, v33
    v_cvt_pk_f16_f32 v33, v58, v59
    v_lshlrev_b32 v56, 16, v34
    v_and_b32 v57, 0xffff0000, v34
    v_cvt_pk_f16_f32 v34, v56, v57
    v_lshlrev_b32 v58, 16, v35
    v_and_b32 v59, 0xffff0000, v35
    v_cvt_pk_f16_f32 v35, v58, v59
    v_max3_f32 v56, abs(v56), abs(v57), abs(v58)
    v_cmp_le_f32 vcc, 0x3a800000, v56
    s_cbranch_vccnz L_wok30
    s_mov_b64 exec, 1
    ds_add_u32 v165, v166 offset:56
    s_mov_b64 exec, -1
L_wok30:
    s_waitcnt vmcnt(11)
    v_lshlrev_b32 v56, 16, v36
    v_and_b32 v57, 0xffff0000, v36
    v_cvt_pk_f16_f32 v36, v56, v57
    v_lshlrev_b32 v58, 16, v37
    v_and_b32 v59, 0xffff0000, v37
    v_cvt_pk_f16_f32 v37, v58, v59
    v_lshlrev_b32 v56, 16, v38
    v_and_b32 v57, 0xffff0000, v38
    v_cvt_pk_f16_f32 v38, v56, v57
    v_lshlrev_b32 v58, 16, v39
    v_and_b32 v59, 0xffff0000, v39
    v_cvt_pk_f16_f32 v39, v58, v59
    s_waitcnt vmcnt(10)
    v_lshlrev_b32 v56, 16, v40
    v_and_b32 v57, 0xffff0000, v40
    v_cvt_pk_f16_f32 v40, v56, v57
    v_lshlrev_b32 v58, 16, v41
    v_and_b32 v59, 0xffff0000, v41
    v_cvt_pk_f16_f32 v41, v58, v59
    v_lshlrev_b32 v56, 16, v42
    v_and_b32 v57, 0xffff0000, v42
    v_cvt_pk_f16_f32 v42, v56, v57
    v_lshlrev_b32 v58, 16, v43
    v_and_b32 v59, 0xffff0000, v43
    v_cvt_pk_f16_f32 v43, v58, v59
    s_waitcnt vmcnt(9)
    v_lshlrev_b32 v56, 16, v44
    v_and_b32 v57, 0xffff0000, v44
    v_cvt_pk_f16_f32 v44, v56, v57
    v_lshlrev_b32 v58, 16, v45
    v_and_b32 v59, 0xffff0000, v45
    v_cvt_pk_f16_f32 v45, v58, v59
    v_lshlrev_b32 v56, 16, v46
    v_and_b32 v57, 0xffff0000, v46
    v_cvt_pk_f16_f32 v46, v56, v57
    v_lshlrev_b32 v58, 16, v47
    v_and_b32 v59, 0xffff0000, v47
    v_cvt_pk_f16_f32 v47, v58, v59
    s_waitcnt vmcnt(8)
    v_lshlrev_b32 v56, 16, v48
    v_and_b32 v57, 0xffff0000, v48
    v_cvt_pk_f16_f32 v48, v56, v57
    v_lshlrev_b32 v58, 16, v49
    v_and_b32 v59, 0xffff0000, v49
    v_cvt_pk_f16_f32 v49, v58, v59
    v_lshlrev_b32 v56, 16, v50
    v_and_b32 v57, 0xffff0000, v50
    v_cvt_pk_f16_f32 v50, v56, v57
    v_lshlrev_b32 v58, 16, v51
    v_and_b32 v59, 0xffff0000, v51
    v_cvt_pk_f16_f32 v51, v58, v59
    s_waitcnt vmcnt(7)
    v_lshlrev_b32 v56, 16, v52
    v_and_b32 v57, 0xffff0000, v52
    v_cvt_pk_f16_f32 v52, v56, v57
    v_lshlrev_b32 v58, 16, v53
    v_and_b32 v59, 0xffff0000, v53
    v_cvt_pk_f16_f32 v53, v58, v59
    v_and_b32 v53, v8, v53
    v_lshlrev_b32 v56, 16, v54
    v_and_b32 v57, 0xffff0000, v54
    v_cvt_pk_f16_f32 v54, v56, v57
    v_and_b32 v54, v8, v54
    v_lshlrev_b32 v58, 16, v55
    v_and_b32 v59, 0xffff0000, v55
    v_cvt_pk_f16_f32 v55, v58, v59
    v_and_b32 v55, v8, v55
    s_waitcnt vmcnt(2)
    v_lshlrev_b32 v56, 16, v9
    v_and_b32 v57, 0xffff0000, v9
    v_cmp_eq_u32 vcc, 2, v11
    s_nop 1
    v_cndmask_b32 v56, v56, v57, vcc
    v_cmp_eq_u32 vcc, 0, v11
    s_nop 1
    v_cndmask_b32 v57, v12, v57, vcc
    v_cvt_pk_f16_f32 v9, v56, v57
    v_mov_b32 v58, 0
    v_max3_f32 v56, abs(v56), abs(v57), abs(v58)
    v_cmp_le_f32 vcc, 0x3a800000, v56
    s_cbranch_vccnz L_wok31
    s_mov_b64 exec, 1
    ds_add_u32 v165, v166 offset:56
    s_mov_b64 exec, -1
L_wok31:
    ds_write_b128 v4, v[16:19] offset:0
    ds_write_b128 v4, v[20:23] offset:4272
    ds_write_b128 v4, v[24:27] offset:8544
    ds_write_b128 v4, v[28:31] offset:12816
    ds_write_b128 v4, v[32:35] offset:17088
    ds_write_b128 v4, v[36:39] offset:21360
    ds_write_b128 v4, v[40:43] offset:25632
    ds_write_b128 v4, v[44:47] offset:29904
    ds_write_b128 v4, v[48:51] offset:34176
    ds_write_b128 v6, v[52:55]
    ds_write_b128 v7, v[12:15]
    s_cmp_lg_u32 s47, 3
    s_cbranch_scc1 L_pw32
    s_mov_b32 exec_lo, 0x3fff
    s_mov_b32 exec_hi, 0x0
    ds_write_b32 v10, v9
    s_mov_b64 exec, -1
L_pw32:
    s_waitcnt lgkmcnt(0)
    s_mov_b64 exec, 1
    ds_add_u32 v165, v166 offset:12
    s_mov_b64 exec, -1
    v_add_u32 v4, 4294928848, v4
    v_add_u32 v6, 4294928848, v6
    v_add_u32 v7, 4294928848, v7
    s_mov_b32 s41, 70304
    buffer_load_dwordx4 v[16:19], v2, s[12:15], s41 offen
    s_mov_b32 s41, 74360
    buffer_load_dwordx4 v[20:23], v2, s[12:15], s41 offen
    s_mov_b32 s41, 78416
    buffer_load_dwordx4 v[24:27], v2, s[12:15], s41 offen
    s_mov_b32 s41, 82472
    buffer_load_dwordx4 v[28:31], v2, s[12:15], s41 offen
    s_mov_b32 s41, 86528
    buffer_load_dwordx4 v[32:35], v2, s[12:15], s41 offen
    s_mov_b32 s41, 90584
    buffer_load_dwordx4 v[36:39], v2, s[12:15], s41 offen
    s_mov_b32 s41, 94640
    buffer_load_dwordx4 v[40:43], v2, s[12:15], s41 offen
    s_mov_b32 s41, 98696
    buffer_load_dwordx4 v[44:47], v2, s[12:15], s41 offen
    s_mov_b32 s41, 102752
    buffer_load_dwordx4 v[48:51], v3, s[12:15], s41 offen
    s_mov_b32 s41, 70304
    buffer_load_dwordx4 v[52:55], v5, s[12:15], s41 offen
    v_and_b32 v56, 0xff, v105
    v_bfe_u32 v57, v105, 8, 8
    v_bfe_u32 v58, v105, 16, 8
    v_lshrrev_b32 v59, 28, v105
    v_mul_u32_u24 v100, 112, v56
    v_lshl_add_u32 v100, v57, 2, v100
    v_mul_u32_u24 v101, 112, v57
    v_lshl_add_u32 v101, v56, 2, v101
    v_mul_u32_u24 v56, 1456, v59
    v_add_u32 v56, 0, v56
    v_add_u32 v100, v100, v56
    v_add_u32 v101, v101, v56
    v_mul_u32_u24 v56, 816, v59
    v_lshl_add_u32 v102, v58, 2, v56
    v_add_u32 v102, 82656, v102
    v_bfe_u32 v57, v105, 24, 1
    v_mov_b32 v56, 0x0c0c0c0c
    v_cmp_eq_u32 vcc, 0, v57
    v_mov_b32 v103, 0x05040100
    v_mov_b32 v104, 0x07060302
    v_cndmask_b32 v103, v56, v103, vcc
    v_cndmask_b32 v104, v56, v104, vcc
    s_branch L_wf34
L_wf33:
    s_sleep 1
L_wf34:
    ds_read_b32 v167, v165 offset:12
    s_waitcnt lgkmcnt(0)
    v_readfirstlane_b32 s40, v167
    s_cmp_lt_u32 s40, 4
    s_cbranch_scc1 L_wf33
    s_mov_b32 s40, 0x4000400
    v_pk_add_u16 v106, v106, s40
    v_lshlrev_b32 v56, 2, v1
    v_add_u32 v56, 161632, v56
    s_mov_b64 exec, 0x1fff
    ds_write_b32 v56, v106
    s_mov_b64 exec, -1
    v_and_b32 v56, 15, v1
    v_pk_add_u16 v116, v116, s40
    v_pk_add_u16 v117, v117, s40
    v_pk_add_u16 v118, v118, s40
    v_pk_add_u16 v119, v119, s40
    v_cmp_eq_u32 vcc, 0, v56
    s_nop 1
    v_cndmask_b32 v64, v12, v116, vcc
    v_cndmask_b32 v65, v12, v117, vcc
    v_cndmask_b32 v66, v12, v118, vcc
    v_cndmask_b32 v67, v12, v119, vcc
    v_cmp_eq_u32 vcc, 4, v56
    s_nop 1
    v_cndmask_b32 v68, v12, v116, vcc
    v_cndmask_b32 v69, v12, v117, vcc
    v_cndmask_b32 v70, v12, v118, vcc
    v_cndmask_b32 v71, v12, v119, vcc
    v_cmp_eq_u32 vcc, 8, v56
    s_nop 1
    v_cndmask_b32 v72, v12, v116, vcc
    v_cndmask_b32 v73, v12, v117, vcc
    v_cndmask_b32 v74, v12, v118, vcc
    v_cndmask_b32 v75, v12, v119, vcc
    v_cmp_eq_u32 vcc, 12, v56
    s_nop 1
    v_cndmask_b32 v76, v12, v116, vcc
    v_cndmask_b32 v77, v12, v117, vcc
    v_cndmask_b32 v78, v12, v118, vcc
    v_cndmask_b32 v79, v12, v119, vcc
    v_cmp_eq_u32 vcc, 6, v56
    v_lshlrev_b32 v97, 16, v107
    v_mul_f32 v97, 0x43800000, v97
    v_cvt_pk_f16_f32 v97, 0, v97
    v_cndmask_b32 v97, v12, v97, vcc
    v_lshlrev_b32 v98, 16, v108
    v_mul_f32 v98, 0x43800000, v98
    v_cvt_pk_f16_f32 v98, 0, v98
    v_cndmask_b32 v98, v12, v98, vcc
    s_waitcnt vmcnt(9)
    v_lshlrev_b32 v56, 16, v16
    v_and_b32 v57, 0xffff0000, v16
    v_cvt_pk_f16_f32 v16, v56, v57
    v_lshlrev_b32 v58, 16, v17
    v_and_b32 v59, 0xffff0000, v17
    v_cvt_pk_f16_f32 v17, v58, v59
    v_lshlrev_b32 v56, 16, v18
    v_and_b32 v57, 0xffff0000, v18
    v_cvt_pk_f16_f32 v18, v56, v57
    v_lshlrev_b32 v58, 16, v19
    v_and_b32 v59, 0xffff0000, v19
    v_cvt_pk_f16_f32 v19, v58, v59
    s_waitcnt vmcnt(8)
    v_lshlrev_b32 v56, 16, v20
    v_and_b32 v57, 0xffff0000, v20
    v_cvt_pk_f16_f32 v20, v56, v57
    v_lshlrev_b32 v58, 16, v21
    v_and_b32 v59, 0xffff0000, v21
    v_cvt_pk_f16_f32 v21, v58, v59
    v_lshlrev_b32 v56, 16, v22
    v_and_b32 v57, 0xffff0000, v22
    v_cvt_pk_f16_f32 v22, v56, v57
    v_lshlrev_b32 v58, 16, v23
    v_and_b32 v59, 0xffff0000, v23
    v_cvt_pk_f16_f32 v23, v58, v59
    s_waitcnt vmcnt(7)
    v_lshlrev_b32 v56, 16, v24
    v_and_b32 v57, 0xffff0000, v24
    v_cvt_pk_f16_f32 v24, v56, v57
    v_lshlrev_b32 v58, 16, v25
    v_and_b32 v59, 0xffff0000, v25
    v_cvt_pk_f16_f32 v25, v58, v59
    v_lshlrev_b32 v56, 16, v26
    v_and_b32 v57, 0xffff0000, v26
    v_cvt_pk_f16_f32 v26, v56, v57
    v_lshlrev_b32 v58, 16, v27
    v_and_b32 v59, 0xffff0000, v27
    v_cvt_pk_f16_f32 v27, v58, v59
    v_lshrrev_b32 v56, 5, v1
    v_lshlrev_b32 v56, 4, v56
    v_lshl_add_u32 v144, v144, 5, v56
    v_lshl_add_u32 v145, v145, 5, v56
    v_lshl_add_u32 v146, v146, 5, v56
    s_branch L_wf36
L_wf35:
    s_sleep 2
L_wf36:
    ds_read_b32 v167, v165 offset:16
    s_waitcnt lgkmcnt(0)
    v_readfirstlane_b32 s40, v167
    s_cmp_lt_u32 s40, 4
    s_cbranch_scc1 L_wf35
    s_add_u32 m0, s45, 0
    s_nop 0
    buffer_load_dwordx4 v144, s[8:11], 0 offen lds
    s_add_u32 m0, s45, 2048
    s_nop 0
    buffer_load_dwordx4 v145, s[8:11], 0 offen lds
    s_add_u32 m0, s45, 4096
    s_nop 0
    buffer_load_dwordx4 v146, s[8:11], 0 offen lds
    s_waitcnt vmcnt(9)
    v_lshlrev_b32 v56, 16, v28
    v_and_b32 v57, 0xffff0000, v28
    v_cvt_pk_f16_f32 v28, v56, v57
    v_lshlrev_b32 v58, 16, v29
    v_and_b32 v59, 0xffff0000, v29
    v_cvt_pk_f16_f32 v29, v58, v59
    v_lshlrev_b32 v56, 16, v30
    v_and_b32 v57, 0xffff0000, v30
    v_cvt_pk_f16_f32 v30, v56, v57
    v_lshlrev_b32 v58, 16, v31
    v_and_b32 v59, 0xffff0000, v31
    v_cvt_pk_f16_f32 v31, v58, v59
    s_waitcnt vmcnt(8)
    v_lshlrev_b32 v56, 16, v32
    v_and_b32 v57, 0xffff0000, v32
    v_cvt_pk_f16_f32 v32, v56, v57
    v_lshlrev_b32 v58, 16, v33
    v_and_b32 v59, 0xffff0000, v33
    v_cvt_pk_f16_f32 v33, v58, v59
    v_lshlrev_b32 v56, 16, v34
    v_and_b32 v57, 0xffff0000, v34
    v_cvt_pk_f16_f32 v34, v56, v57
    v_lshlrev_b32 v58, 16, v35
    v_and_b32 v59, 0xffff0000, v35
    v_cvt_pk_f16_f32 v35, v58, v59
    v_max3_f32 v56, abs(v56), abs(v57), abs(v58)
    v_cmp_le_f32 vcc, 0x3a800000, v56
    s_cbranch_vccnz L_wok37
    s_mov_b64 exec, 1
    ds_add_u32 v165, v166 offset:56
    s_mov_b64 exec, -1
L_wok37:
    s_waitcnt vmcnt(7)
    v_lshlrev_b32 v56, 16, v36
    v_and_b32 v57, 0xffff0000, v36
    v_cvt_pk_f16_f32 v36, v56, v57
    v_lshlrev_b32 v58, 16, v37
    v_and_b32 v59, 0xffff0000, v37
    v_cvt_pk_f16_f32 v37, v58, v59
    v_lshlrev_b32 v56, 16, v38
    v_and_b32 v57, 0xffff0000, v38
    v_cvt_pk_f16_f32 v38, v56, v57
    v_lshlrev_b32 v58, 16, v39
    v_and_b32 v59, 0xffff0000, v39
    v_cvt_pk_f16_f32 v39, v58, v59
    s_waitcnt vmcnt(0)
    s_waitcnt lgkmcnt(0)
    s_mov_b64 exec, 1
    ds_add_u32 v165, v166 offset:52
    s_mov_b64 exec, -1
    v_lshlrev_b32 v56, 16, v40
    v_and_b32 v57, 0xffff0000, v40
    v_cvt_pk_f16_f32 v40, v56, v57
    v_lshlrev_b32 v58, 16, v41
    v_and_b32 v59, 0xffff0000, v41
    v_cvt_pk_f16_f32 v41, v58, v59
    v_lshlrev_b32 v56, 16, v42
    v_and_b32 v57, 0xffff0000, v42
    v_cvt_pk_f16_f32 v42, v56, v57
    v_lshlrev_b32 v58, 16, v43
    v_and_b32 v59, 0xffff0000, v43
    v_cvt_pk_f16_f32 v43, v58, v59
    v_lshlrev_b32 v56, 16, v44
    v_and_b32 v57, 0xffff0000, v44
    v_cvt_pk_f16_f32 v44, v56, v57
    v_lshlrev_b32 v58, 16, v45
    v_and_b32 v59, 0xffff0000, v45
    v_cvt_pk_f16_f32 v45, v58, v59
    v_lshlrev_b32 v56, 16, v46
    v_and_b32 v57, 0xffff0000, v46
    v_cvt_pk_f16_f32 v46, v56, v57
    v_lshlrev_b32 v58, 16, v47
    v_and_b32 v59, 0xffff0000, v47
    v_cvt_pk_f16_f32 v47, v58, v59
    v_lshlrev_b32 v56, 16, v48
    v_and_b32 v57, 0xffff0000, v48
    v_cvt_pk_f16_f32 v48, v56, v57
    v_lshlrev_b32 v58, 16, v49
    v_and_b32 v59, 0xffff0000, v49
    v_cvt_pk_f16_f32 v49, v58, v59
    v_lshlrev_b32 v56, 16, v50
    v_and_b32 v57, 0xffff0000, v50
    v_cvt_pk_f16_f32 v50, v56, v57
    v_lshlrev_b32 v58, 16, v51
    v_and_b32 v59, 0xffff0000, v51
    v_cvt_pk_f16_f32 v51, v58, v59
    v_lshlrev_b32 v56, 16, v52
    v_and_b32 v57, 0xffff0000, v52
    v_cvt_pk_f16_f32 v52, v56, v57
    v_lshlrev_b32 v58, 16, v53
    v_and_b32 v59, 0xffff0000, v53
    v_cvt_pk_f16_f32 v53, v58, v59
    v_and_b32 v53, v8, v53
    v_lshlrev_b32 v56, 16, v54
    v_and_b32 v57, 0xffff0000, v54
    v_cvt_pk_f16_f32 v54, v56, v57
    v_and_b32 v54, v8, v54
    v_lshlrev_b32 v58, 16, v55
    v_and_b32 v59, 0xffff0000, v55
    v_cvt_pk_f16_f32 v55, v58, v59
    v_and_b32 v55, v8, v55
    s_branch L_wf39
L_wf38:
    s_sleep 2
L_wf39:
    ds_read_b32 v167, v165 offset:4
    s_waitcnt lgkmcnt(0)
    v_readfirstlane_b32 s40, v167
    s_cmp_lt_u32 s40, 8
    s_cbranch_scc1 L_wf38
    ds_write_b128 v4, v[16:19] offset:0
    ds_write_b128 v4, v[20:23] offset:4272
    ds_write_b128 v4, v[24:27] offset:8544
    ds_write_b128 v4, v[28:31] offset:12816
    ds_write_b128 v4, v[32:35] offset:17088
    ds_write_b128 v4, v[36:39] offset:21360
    ds_write_b128 v4, v[40:43] offset:25632
    ds_write_b128 v4, v[44:47] offset:29904
    ds_write_b128 v4, v[48:51] offset:34176
    ds_write_b128 v6, v[52:55]
    ds_write_b128 v7, v[12:15]
    s_cmp_lg_u32 s47, 3
    s_cbranch_scc1 L_pw40
    s_mov_b32 exec_lo, 0xfffc000
    s_mov_b32 exec_hi, 0x0
    ds_write_b32 v10, v9
    s_mov_b64 exec, -1
L_pw40:
    s_waitcnt lgkmcnt(0)
    s_mov_b64 exec, 1
    ds_add_u32 v165, v166 offset:12
    s_mov_b64 exec, -1
    v_add_u32 v4, 38448, v4
    v_add_u32 v6, 38448, v6
    v_add_u32 v7, 38448, v7
    s_mov_b32 s41, 105456
    buffer_load_dwordx4 v[16:19], v2, s[12:15], s41 offen
    s_mov_b32 s41, 109512
    buffer_load_dwordx4 v[20:23], v2, s[12:15], s41 offen
    s_mov_b32 s41, 113568
    buffer_load_dwordx4 v[24:27], v2, s[12:15], s41 offen
    s_mov_b32 s41, 117624
    buffer_load_dwordx4 v[28:31], v2, s[12:15], s41 offen
    s_mov_b32 s41, 121680
    buffer_load_dwordx4 v[32:35], v2, s[12:15], s41 offen
    s_mov_b32 s41, 125736
    buffer_load_dwordx4 v[36:39], v2, s[12:15], s41 offen
    s_mov_b32 s41, 129792
    buffer_load_dwordx4 v[40:43], v2, s[12:15], s41 offen
    s_mov_b32 s41, 133848
    buffer_load_dwordx4 v[44:47], v2, s[12:15], s41 offen
    s_mov_b32 s41, 137904
    buffer_load_dwordx4 v[48:51], v3, s[12:15], s41 offen
    s_mov_b32 s41, 105456
    buffer_load_dwordx4 v[52:55], v5, s[12:15], s41 offen
    s_waitcnt vmcnt(9)
    v_lshlrev_b32 v56, 16, v16
    v_and_b32 v57, 0xffff0000, v16
    v_cvt_pk_f16_f32 v16, v56, v57
    v_lshlrev_b32 v58, 16, v17
    v_and_b32 v59, 0xffff0000, v17
    v_cvt_pk_f16_f32 v17, v58, v59
    v_lshlrev_b32 v56, 16, v18
    v_and_b32 v57, 0xffff0000, v18
    v_cvt_pk_f16_f32 v18, v56, v57
    v_lshlrev_b32 v58, 16, v19
    v_and_b32 v59, 0xffff0000, v19
    v_cvt_pk_f16_f32 v19, v58, v59
    s_waitcnt vmcnt(8)
    v_lshlrev_b32 v56, 16, v20
    v_and_b32 v57, 0xffff0000, v20
    v_cvt_pk_f16_f32 v20, v56, v57
    v_lshlrev_b32 v58, 16, v21
    v_and_b32 v59, 0xffff0000, v21
    v_cvt_pk_f16_f32 v21, v58, v59
    v_lshlrev_b32 v56, 16, v22
    v_and_b32 v57, 0xffff0000, v22
    v_cvt_pk_f16_f32 v22, v56, v57
    v_lshlrev_b32 v58, 16, v23
    v_and_b32 v59, 0xffff0000, v23
    v_cvt_pk_f16_f32 v23, v58, v59
    s_waitcnt vmcnt(7)
    v_lshlrev_b32 v56, 16, v24
    v_and_b32 v57, 0xffff0000, v24
    v_cvt_pk_f16_f32 v24, v56, v57
    v_lshlrev_b32 v58, 16, v25
    v_and_b32 v59, 0xffff0000, v25
    v_cvt_pk_f16_f32 v25, v58, v59
    v_lshlrev_b32 v56, 16, v26
    v_and_b32 v57, 0xffff0000, v26
    v_cvt_pk_f16_f32 v26, v56, v57
    v_lshlrev_b32 v58, 16, v27
    v_and_b32 v59, 0xffff0000, v27
    v_cvt_pk_f16_f32 v27, v58, v59
    s_waitcnt vmcnt(6)
    v_lshlrev_b32 v56, 16, v28
    v_and_b32 v57, 0xffff0000, v28
    v_cvt_pk_f16_f32 v28, v56, v57
    v_lshlrev_b32 v58, 16, v29
    v_and_b32 v59, 0xffff0000, v29
    v_cvt_pk_f16_f32 v29, v58, v59
    v_lshlrev_b32 v56, 16, v30
    v_and_b32 v57, 0xffff0000, v30
    v_cvt_pk_f16_f32 v30, v56, v57
    v_lshlrev_b32 v58, 16, v31
    v_and_b32 v59, 0xffff0000, v31
    v_cvt_pk_f16_f32 v31, v58, v59
    s_waitcnt vmcnt(5)
    v_lshlrev_b32 v56, 16, v32
    v_and_b32 v57, 0xffff0000, v32
    v_cvt_pk_f16_f32 v32, v56, v57
    v_lshlrev_b32 v58, 16, v33
    v_and_b32 v59, 0xffff0000, v33
    v_cvt_pk_f16_f32 v33, v58, v59
    v_lshlrev_b32 v56, 16, v34
    v_and_b32 v57, 0xffff0000, v34
    v_cvt_pk_f16_f32 v34, v56, v57
    v_lshlrev_b32 v58, 16, v35
    v_and_b32 v59, 0xffff0000, v35
    v_cvt_pk_f16_f32 v35, v58, v59
    v_max3_f32 v56, abs(v56), abs(v57), abs(v58)
    v_cmp_le_f32 vcc, 0x3a800000, v56
    s_cbranch_vccnz L_wok41
    s_mov_b64 exec, 1
    ds_add_u32 v165, v166 offset:56
    s_mov_b64 exec, -1
L_wok41:
    s_waitcnt vmcnt(4)
    v_lshlrev_b32 v56, 16, v36
    v_and_b32 v57, 0xffff0000, v36
    v_cvt_pk_f16_f32 v36, v56, v57
    v_lshlrev_b32 v58, 16, v37
    v_and_b32 v59, 0xffff0000, v37
    v_cvt_pk_f16_f32 v37, v58, v59
    v_lshlrev_b32 v56, 16, v38
    v_and_b32 v57, 0xffff0000, v38
    v_cvt_pk_f16_f32 v38, v56, v57
    v_lshlrev_b32 v58, 16, v39
    v_and_b32 v59, 0xffff0000, v39
    v_cvt_pk_f16_f32 v39, v58, v59
    s_waitcnt vmcnt(3)
    v_lshlrev_b32 v56, 16, v40
    v_and_b32 v57, 0xffff0000, v40
    v_cvt_pk_f16_f32 v40, v56, v57
    v_lshlrev_b32 v58, 16, v41
    v_and_b32 v59, 0xffff0000, v41
    v_cvt_pk_f16_f32 v41, v58, v59
    v_lshlrev_b32 v56, 16, v42
    v_and_b32 v57, 0xffff0000, v42
    v_cvt_pk_f16_f32 v42, v56, v57
    v_lshlrev_b32 v58, 16, v43
    v_and_b32 v59, 0xffff0000, v43
    v_cvt_pk_f16_f32 v43, v58, v59
    s_waitcnt vmcnt(2)
    v_lshlrev_b32 v56, 16, v44
    v_and_b32 v57, 0xffff0000, v44
    v_cvt_pk_f16_f32 v44, v56, v57
    v_lshlrev_b32 v58, 16, v45
    v_and_b32 v59, 0xffff0000, v45
    v_cvt_pk_f16_f32 v45, v58, v59
    v_lshlrev_b32 v56, 16, v46
    v_and_b32 v57, 0xffff0000, v46
    v_cvt_pk_f16_f32 v46, v56, v57
    v_lshlrev_b32 v58, 16, v47
    v_and_b32 v59, 0xffff0000, v47
    v_cvt_pk_f16_f32 v47, v58, v59
    s_waitcnt vmcnt(1)
    v_lshlrev_b32 v56, 16, v48
    v_and_b32 v57, 0xffff0000, v48
    v_cvt_pk_f16_f32 v48, v56, v57
    v_lshlrev_b32 v58, 16, v49
    v_and_b32 v59, 0xffff0000, v49
    v_cvt_pk_f16_f32 v49, v58, v59
    v_lshlrev_b32 v56, 16, v50
    v_and_b32 v57, 0xffff0000, v50
    v_cvt_pk_f16_f32 v50, v56, v57
    v_lshlrev_b32 v58, 16, v51
    v_and_b32 v59, 0xffff0000, v51
    v_cvt_pk_f16_f32 v51, v58, v59
    s_waitcnt vmcnt(0)
    v_lshlrev_b32 v56, 16, v52
    v_and_b32 v57, 0xffff0000, v52
    v_cvt_pk_f16_f32 v52, v56, v57
    v_lshlrev_b32 v58, 16, v53
    v_and_b32 v59, 0xffff0000, v53
    v_cvt_pk_f16_f32 v53, v58, v59
    v_and_b32 v53, v8, v53
    v_lshlrev_b32 v56, 16, v54
    v_and_b32 v57, 0xffff0000, v54
    v_cvt_pk_f16_f32 v54, v56, v57
    v_and_b32 v54, v8, v54
    v_lshlrev_b32 v58, 16, v55
    v_and_b32 v59, 0xffff0000, v55
    v_cvt_pk_f16_f32 v55, v58, v59
    v_and_b32 v55, v8, v55
    s_branch L_wf43
L_wf42:
    s_sleep 4
L_wf43:
    ds_read_b32 v167, v165 offset:24
    s_waitcnt lgkmcnt(0)
    v_readfirstlane_b32 s40, v167
    s_cmp_lt_u32 s40, 4
    s_cbranch_scc1 L_wf42
    s_lshl_b32 s43, s47, 10
    s_add_u32 m0, s43, 0
    s_mov_b32 s41, 175760
    buffer_load_dwordx4 v99, s[12:15], s41 offen lds
    s_add_u32 m0, s43, 4096
    s_mov_b32 s41, 179856
    buffer_load_dwordx4 v99, s[12:15], s41 offen lds
    s_add_u32 m0, s43, 8192
    s_mov_b32 s41, 183952
    buffer_load_dwordx4 v99, s[12:15], s41 offen lds
    s_add_u32 m0, s43, 12288
    s_mov_b32 s41, 188048
    buffer_load_dwordx4 v99, s[12:15], s41 offen lds
    s_add_u32 m0, s43, 16384
    s_mov_b32 s41, 192144
    buffer_load_dwordx4 v99, s[12:15], s41 offen lds
    s_add_u32 m0, s43, 20480
    s_mov_b32 s41, 196240
    buffer_load_dwordx4 v99, s[12:15], s41 offen lds
    s_add_u32 m0, s43, 24576
    s_mov_b32 s41, 200336
    buffer_load_dwordx4 v99, s[12:15], s41 offen lds
    s_add_u32 m0, s43, 28672
    s_mov_b32 s41, 204432
    buffer_load_dwordx4 v99, s[12:15], s41 offen lds
    s_add_u32 m0, s43, 32768
    s_mov_b32 s41, 208528
    buffer_load_dwordx4 v99, s[12:15], s41 offen lds
    s_add_u32 m0, s43, 40960
    s_mov_b32 s41, 140608
    buffer_load_dwordx4 v99, s[12:15], s41 offen lds
    s_add_u32 m0, s43, 45056
    s_mov_b32 s41, 144704
    buffer_load_dwordx4 v99, s[12:15], s41 offen lds
    s_add_u32 m0, s43, 49152
    s_mov_b32 s41, 148800
    buffer_load_dwordx4 v99, s[12:15], s41 offen lds
    s_add_u32 m0, s43, 53248
    s_mov_b32 s41, 152896
    buffer_load_dwordx4 v99, s[12:15], s41 offen lds
    s_add_u32 m0, s43, 57344
    s_mov_b32 s41, 156992
    buffer_load_dwordx4 v99, s[12:15], s41 offen lds
    s_add_u32 m0, s43, 61440
    s_mov_b32 s41, 161088
    buffer_load_dwordx4 v99, s[12:15], s41 offen lds
    s_add_u32 m0, s43, 65536
    s_mov_b32 s41, 165184
    buffer_load_dwordx4 v99, s[12:15], s41 offen lds
    s_add_u32 m0, s43, 69632
    s_mov_b32 s41, 169280
    buffer_load_dwordx4 v99, s[12:15], s41 offen lds
    s_add_u32 m0, s43, 73728
    s_mov_b32 s41, 173376
    buffer_load_dwordx4 v99, s[12:15], s41 offen lds
    s_branch L_wf45
L_wf44:
    s_sleep 4
L_wf45:
    ds_read_b32 v167, v165 offset:16
    s_waitcnt lgkmcnt(0)
    v_readfirstlane_b32 s40, v167
    s_cmp_lt_u32 s40, 8
    s_cbranch_scc1 L_wf44
    ds_write_b128 v4, v[16:19] offset:0
    ds_write_b128 v4, v[20:23] offset:4272
    ds_write_b128 v4, v[24:27] offset:8544
    ds_write_b128 v4, v[28:31] offset:12816
    ds_write_b128 v4, v[32:35] offset:17088
    ds_write_b128 v4, v[36:39] offset:21360
    ds_write_b128 v4, v[40:43] offset:25632
    ds_write_b128 v4, v[44:47] offset:29904
    ds_write_b128 v4, v[48:51] offset:34176
    ds_write_b128 v6, v[52:55]
    ds_write_b128 v7, v[12:15]
    s_cmp_lg_u32 s47, 3
    s_cbranch_scc1 L_pw46
    s_mov_b32 exec_lo, 0xf0000000
    s_mov_b32 exec_hi, 0x3ff
    ds_write_b32 v10, v9
    s_mov_b64 exec, -1
L_pw46:
    s_waitcnt lgkmcnt(0)
    s_mov_b64 exec, 1
    ds_add_u32 v165, v166 offset:12
    s_mov_b64 exec, -1
    s_waitcnt vmcnt(0)
    s_waitcnt lgkmcnt(0)
    s_mov_b64 exec, 1
    ds_add_u32 v165, v166 offset:28
    s_mov_b64 exec, -1
    s_branch L_wf48
L_wf47:
    s_sleep 1
L_wf48:
    ds_read_b32 v167, v165 offset:28
    s_waitcnt lgkmcnt(0)
    v_readfirstlane_b32 s40, v167
    s_cmp_lt_u32 s40, 4
    s_cbranch_scc1 L_wf47
    ds_read_b64_tr_b16 v[112:113], v80 offset:0
    ds_read_b64_tr_b16 v[114:115], v81 offset:0
    ds_read_b64_tr_b16 v[116:117], v80 offset:32
    ds_read_b64_tr_b16 v[118:119], v81 offset:32
    ds_read_b64_tr_b16 v[120:121], v80 offset:64
    ds_read_b64_tr_b16 v[122:123], v81 offset:64
    ds_read_b64_tr_b16 v[124:125], v80 offset:96
    ds_read_b64_tr_b16 v[126:127], v81 offset:96
    s_waitcnt lgkmcnt(0)
    s_setprio 3
    v_mfma_f32_16x16x32_bf16 v[128:131], v[64:67], v[112:115], 0
    v_mfma_f32_16x16x32_bf16 v[128:131], v[68:71], v[116:119], v[128:131]
    v_mfma_f32_16x16x32_bf16 v[128:131], v[72:75], v[120:123], v[128:131]
    v_mfma_f32_16x16x32_bf16 v[128:131], v[76:79], v[124:127], v[128:131]
    s_setprio 1
    ds_read_b64_tr_b16 v[112:113], v80 offset:512
    ds_read_b64_tr_b16 v[114:115], v81 offset:512
    ds_read_b64_tr_b16 v[116:117], v80 offset:544
    ds_read_b64_tr_b16 v[118:119], v81 offset:544
    ds_read_b64_tr_b16 v[120:121], v80 offset:576
    ds_read_b64_tr_b16 v[122:123], v81 offset:576
    ds_read_b64_tr_b16 v[124:125], v80 offset:608
    ds_read_b64_tr_b16 v[126:127], v81 offset:608
    s_waitcnt lgkmcnt(0)
    s_setprio 3
    v_mfma_f32_16x16x32_bf16 v[132:135], v[64:67], v[112:115], 0
    v_mfma_f32_16x16x32_bf16 v[132:135], v[68:71], v[116:119], v[132:135]
    v_mfma_f32_16x16x32_bf16 v[132:135], v[72:75], v[120:123], v[132:135]
    v_mfma_f32_16x16x32_bf16 v[132:135], v[76:79], v[124:127], v[132:135]
    s_setprio 1
    ds_read_b64_tr_b16 v[112:113], v80 offset:1024
    ds_read_b64_tr_b16 v[114:115], v81 offset:1024
    ds_read_b64_tr_b16 v[116:117], v80 offset:1056
    ds_read_b64_tr_b16 v[118:119], v81 offset:1056
    ds_read_b64_tr_b16 v[120:121], v80 offset:1088
    ds_read_b64_tr_b16 v[122:123], v81 offset:1088
    ds_read_b64_tr_b16 v[124:125], v80 offset:1120
    ds_read_b64_tr_b16 v[126:127], v81 offset:1120
    s_waitcnt lgkmcnt(0)
    s_setprio 3
    v_mfma_f32_16x16x32_bf16 v[136:139], v[64:67], v[112:115], 0
    v_mfma_f32_16x16x32_bf16 v[136:139], v[68:71], v[116:119], v[136:139]
    v_mfma_f32_16x16x32_bf16 v[136:139], v[72:75], v[120:123], v[136:139]
    v_mfma_f32_16x16x32_bf16 v[136:139], v[76:79], v[124:127], v[136:139]
    s_setprio 1
    s_nop 6
    v_cvt_pk_bf16_f32 v128, v128, 0
    ds_write_b16 v82, v128
    v_cvt_pk_bf16_f32 v132, v132, 0
    ds_write_b16 v83, v132
    v_cvt_pk_bf16_f32 v136, v136, 0
    ds_write_b16 v84, v136
    s_waitcnt lgkmcnt(0)
    s_mov_b64 exec, 1
    ds_add_u32 v165, v166 offset:32
    s_mov_b64 exec, -1
    ds_read_b64_tr_b16 v[112:113], v85 offset:0
    ds_read_b64_tr_b16 v[114:115], v85 offset:5408
    ds_read_b64_tr_b16 v[116:117], v86 offset:0
    ds_read_b64_tr_b16 v[118:119], v87 offset:0
    ds_read_b64_tr_b16 v[120:121], v85 offset:64
    ds_read_b64_tr_b16 v[122:123], v85 offset:5472
    ds_read_b64_tr_b16 v[124:125], v86 offset:64
    ds_read_b64_tr_b16 v[126:127], v87 offset:64
    s_branch L_wf50
L_wf49:
    s_sleep 1
L_wf50:
    ds_read_b32 v167, v165 offset:32
    s_waitcnt lgkmcnt(0)
    v_readfirstlane_b32 s40, v167
    s_cmp_lt_u32 s40, 4
    s_cbranch_scc1 L_wf49
    ds_read_b128 v[64:67], v89
    ds_read_b128 v[68:71], v89 offset:32
    s_waitcnt lgkmcnt(0)
    s_setprio 3
    v_mfma_f32_32x32x16_bf16 v[16:31], v[64:67], v[112:115], 0
    v_mfma_f32_32x32x16_bf16 v[16:31], v[68:71], v[116:119], v[16:31]
    v_mfma_f32_32x32x16_bf16 v[32:47], v[64:67], v[120:123], 0
    v_mfma_f32_32x32x16_bf16 v[32:47], v[68:71], v[124:127], v[32:47]
    s_setprio 1
    ds_read_b64_tr_b16 v[112:113], v85 offset:512
    ds_read_b64_tr_b16 v[114:115], v85 offset:5920
    ds_read_b64_tr_b16 v[116:117], v86 offset:512
    ds_read_b64_tr_b16 v[118:119], v87 offset:512
    ds_read_b64_tr_b16 v[120:121], v85 offset:576
    ds_read_b64_tr_b16 v[122:123], v85 offset:5984
    ds_read_b64_tr_b16 v[124:125], v86 offset:576
    ds_read_b64_tr_b16 v[126:127], v87 offset:576
    s_waitcnt lgkmcnt(0)
    s_setprio 3
    v_mfma_f32_32x32x16_bf16 v[128:143], v[64:67], v[112:115], 0
    v_mfma_f32_32x32x16_bf16 v[128:143], v[68:71], v[116:119], v[128:143]
    v_mfma_f32_32x32x16_bf16 v[148:163], v[64:67], v[120:123], 0
    v_mfma_f32_32x32x16_bf16 v[148:163], v[68:71], v[124:127], v[148:163]
    s_setprio 1
    ds_read_b64_tr_b16 v[112:113], v85 offset:1024
    ds_read_b64_tr_b16 v[114:115], v85 offset:6432
    ds_read_b64_tr_b16 v[116:117], v86 offset:1024
    ds_read_b64_tr_b16 v[118:119], v87 offset:1024
    ds_read_b64_tr_b16 v[120:121], v85 offset:1088
    ds_read_b64_tr_b16 v[122:123], v85 offset:6496
    ds_read_b64_tr_b16 v[124:125], v86 offset:1088
    ds_read_b64_tr_b16 v[126:127], v87 offset:1088
    v_cvt_pk_f16_f32 v16, v16, v17
    v_cvt_pk_f16_f32 v17, v18, v19
    v_cvt_pk_f16_f32 v18, v20, v21
    v_cvt_pk_f16_f32 v19, v22, v23
    v_cvt_pk_f16_f32 v20, v24, v25
    v_cvt_pk_f16_f32 v21, v26, v27
    v_cvt_pk_f16_f32 v22, v28, v29
    v_cvt_pk_f16_f32 v23, v30, v31
    ds_write_b64 v88, v[16:17] offset:0
    ds_write_b64 v88, v[18:19] offset:16
    ds_write_b64 v88, v[20:21] offset:32
    s_mov_b32 exec_hi, 0
    ds_write_b64 v88, v[22:23] offset:48
    s_mov_b32 exec_hi, -1
    v_cvt_pk_f16_f32 v32, v32, v33
    v_cvt_pk_f16_f32 v33, v34, v35
    v_cvt_pk_f16_f32 v34, v36, v37
    v_cvt_pk_f16_f32 v35, v38, v39
    v_cvt_pk_f16_f32 v36, v40, v41
    v_cvt_pk_f16_f32 v37, v42, v43
    v_cvt_pk_f16_f32 v38, v44, v45
    v_cvt_pk_f16_f32 v39, v46, v47
    ds_write_b64 v88, v[32:33] offset:1792
    ds_write_b64 v88, v[34:35] offset:1808
    ds_write_b64 v88, v[36:37] offset:1824
    s_mov_b32 exec_hi, 0
    ds_write_b64 v88, v[38:39] offset:1840
    s_mov_b32 exec_hi, -1
    s_waitcnt lgkmcnt(8)
    s_setprio 3
    v_mfma_f32_32x32x16_bf16 v[16:31], v[64:67], v[112:115], 0
    v_mfma_f32_32x32x16_bf16 v[16:31], v[68:71], v[116:119], v[16:31]
    v_mfma_f32_32x32x16_bf16 v[32:47], v[64:67], v[120:123], 0
    v_mfma_f32_32x32x16_bf16 v[32:47], v[68:71], v[124:127], v[32:47]
    s_setprio 1
    v_cvt_pk_f16_f32 v128, v128, v129
    v_cvt_pk_f16_f32 v129, v130, v131
    v_cvt_pk_f16_f32 v130, v132, v133
    v_cvt_pk_f16_f32 v131, v134, v135
    v_cvt_pk_f16_f32 v132, v136, v137
    v_cvt_pk_f16_f32 v133, v138, v139
    v_cvt_pk_f16_f32 v134, v140, v141
    v_cvt_pk_f16_f32 v135, v142, v143
    ds_write_b64 v88, v[128:129] offset:14336
    ds_write_b64 v88, v[130:131] offset:14352
    ds_write_b64 v88, v[132:133] offset:14368
    s_mov_b32 exec_hi, 0
    ds_write_b64 v88, v[134:135] offset:14384
    s_mov_b32 exec_hi, -1
    v_cvt_pk_f16_f32 v148, v148, v149
    v_cvt_pk_f16_f32 v149, v150, v151
    v_cvt_pk_f16_f32 v150, v152, v153
    v_cvt_pk_f16_f32 v151, v154, v155
    v_cvt_pk_f16_f32 v152, v156, v157
    v_cvt_pk_f16_f32 v153, v158, v159
    v_cvt_pk_f16_f32 v154, v160, v161
    v_cvt_pk_f16_f32 v155, v162, v163
    ds_write_b64 v88, v[148:149] offset:16128
    ds_write_b64 v88, v[150:151] offset:16144
    ds_write_b64 v88, v[152:153] offset:16160
    s_mov_b32 exec_hi, 0
    ds_write_b64 v88, v[154:155] offset:16176
    s_mov_b32 exec_hi, -1
    s_cmp_eq_u32 s47, 3
    s_cbranch_scc1 L_q2skip
    v_cvt_pk_f16_f32 v16, v16, v17
    v_cvt_pk_f16_f32 v17, v18, v19
    v_cvt_pk_f16_f32 v18, v20, v21
    v_cvt_pk_f16_f32 v19, v22, v23
    v_cvt_pk_f16_f32 v20, v24, v25
    v_cvt_pk_f16_f32 v21, v26, v27
    v_cvt_pk_f16_f32 v22, v28, v29
    v_cvt_pk_f16_f32 v23, v30, v31
    ds_write_b64 v88, v[16:17] offset:28672
    ds_write_b64 v88, v[18:19] offset:28688
    ds_write_b64 v88, v[20:21] offset:28704
    s_mov_b32 exec_hi, 0
    ds_write_b64 v88, v[22:23] offset:28720
    s_mov_b32 exec_hi, -1
    v_cvt_pk_f16_f32 v32, v32, v33
    v_cvt_pk_f16_f32 v33, v34, v35
    v_cvt_pk_f16_f32 v34, v36, v37
    v_cvt_pk_f16_f32 v35, v38, v39
    v_cvt_pk_f16_f32 v36, v40, v41
    v_cvt_pk_f16_f32 v37, v42, v43
    v_cvt_pk_f16_f32 v38, v44, v45
    v_cvt_pk_f16_f32 v39, v46, v47
    ds_write_b64 v88, v[32:33] offset:30464
    ds_write_b64 v88, v[34:35] offset:30480
    ds_write_b64 v88, v[36:37] offset:30496
    s_mov_b32 exec_hi, 0
    ds_write_b64 v88, v[38:39] offset:30512
    s_mov_b32 exec_hi, -1
L_q2skip:
    s_waitcnt lgkmcnt(0)
    s_mov_b64 exec, 1
    ds_add_u32 v165, v166 offset:36
    s_mov_b64 exec, -1
    s_branch L_wf52
L_wf51:
    s_sleep 1
L_wf52:
    ds_read_b32 v167, v165 offset:36
    s_waitcnt lgkmcnt(0)
    v_readfirstlane_b32 s40, v167
    s_cmp_lt_u32 s40, 4
    s_cbranch_scc1 L_wf51
    s_branch L_wf54
L_wf53:
    s_sleep 4
L_wf54:
    ds_read_b32 v167, v165 offset:16
    s_waitcnt lgkmcnt(0)
    v_readfirstlane_b32 s40, v167
    s_cmp_lt_u32 s40, 12
    s_cbranch_scc1 L_wf53
    ds_read_u16 v56, v90 offset:52
    ds_read_u16_d16_hi v57, v91 offset:164
    ds_read_u16 v58, v92 offset:52
    ds_read_u16_d16_hi v59, v93 offset:164
    s_mov_b32 s41, 0xffff0000
    ds_read_b32 v112, v100 offset:0
    ds_read_b32 v113, v100 offset:56
    ds_read_b32 v114, v101 offset:0
    ds_read_b32 v115, v101 offset:56
    ds_read_b32 v116, v100 offset:2912
    ds_read_b32 v117, v100 offset:2968
    ds_read_b32 v118, v101 offset:2912
    ds_read_b32 v119, v101 offset:2968
    s_waitcnt lgkmcnt(8)
    v_and_or_b32 v56, v57, s41, v56
    v_and_or_b32 v56, v56, v96, v97
    ds_write_b32 v94, v56
    v_and_or_b32 v58, v59, s41, v58
    v_and_or_b32 v58, v58, v96, v98
    ds_write_b32 v95, v58
    s_waitcnt lgkmcnt(6)
    v_perm_b32 v124, v115, v114, v103
    v_perm_b32 v125, v115, v114, v104
    v_pk_add_f16 v124, v112, v124
    v_pk_add_f16 v125, v113, v125
    ds_read_b32 v120, v100 offset:5824
    ds_read_b32 v121, v100 offset:5880
    ds_read_b32 v122, v101 offset:5824
    ds_read_b32 v123, v101 offset:5880
    ds_write_b32 v102, v124 offset:0
    ds_write_b32 v102, v125 offset:400
    s_waitcnt lgkmcnt(8)
    v_perm_b32 v126, v119, v118, v103
    v_perm_b32 v127, v119, v118, v104
    v_pk_add_f16 v126, v116, v126
    v_pk_add_f16 v127, v117, v127
    ds_read_b32 v112, v100 offset:8736
    ds_read_b32 v113, v100 offset:8792
    ds_read_b32 v114, v101 offset:8736
    ds_read_b32 v115, v101 offset:8792
    ds_write_b32 v102, v126 offset:1632
    ds_write_b32 v102, v127 offset:2032
    s_waitcnt lgkmcnt(8)
    v_perm_b32 v124, v123, v122, v103
    v_perm_b32 v125, v123, v122, v104
    v_pk_add_f16 v124, v120, v124
    v_pk_add_f16 v125, v121, v125
    ds_read_b32 v116, v100 offset:11648
    ds_read_b32 v117, v100 offset:11704
    ds_read_b32 v118, v101 offset:11648
    ds_read_b32 v119, v101 offset:11704
    ds_write_b32 v102, v124 offset:3264
    ds_write_b32 v102, v125 offset:3664
    s_waitcnt lgkmcnt(8)
    v_perm_b32 v126, v115, v114, v103
    v_perm_b32 v127, v115, v114, v104
    v_pk_add_f16 v126, v112, v126
    v_pk_add_f16 v127, v113, v127
    ds_read_b32 v120, v100 offset:14560
    ds_read_b32 v121, v100 offset:14616
    ds_read_b32 v122, v101 offset:14560
    ds_read_b32 v123, v101 offset:14616
    ds_write_b32 v102, v126 offset:4896
    ds_write_b32 v102, v127 offset:5296
    s_waitcnt lgkmcnt(8)
    v_perm_b32 v124, v119, v118, v103
    v_perm_b32 v125, v119, v118, v104
    v_pk_add_f16 v124, v116, v124
    v_pk_add_f16 v125, v117, v125
    ds_read_b32 v112, v100 offset:17472
    ds_read_b32 v113, v100 offset:17528
    ds_read_b32 v114, v101 offset:17472
    ds_read_b32 v115, v101 offset:17528
    ds_write_b32 v102, v124 offset:6528
    ds_write_b32 v102, v125 offset:6928
    s_waitcnt lgkmcnt(8)
    v_perm_b32 v126, v123, v122, v103
    v_perm_b32 v127, v123, v122, v104
    v_pk_add_f16 v126, v120, v126
    v_pk_add_f16 v127, v121, v127
    ds_read_b32 v116, v100 offset:20384
    ds_read_b32 v117, v100 offset:20440
    ds_read_b32 v118, v101 offset:20384
    ds_read_b32 v119, v101 offset:20440
    ds_write_b32 v102, v126 offset:8160
    ds_write_b32 v102, v127 offset:8560
    s_waitcnt lgkmcnt(8)
    v_perm_b32 v124, v115, v114, v103
    v_perm_b32 v125, v115, v114, v104
    v_pk_add_f16 v124, v112, v124
    v_pk_add_f16 v125, v113, v125
    ds_read_b32 v120, v100 offset:23296
    ds_read_b32 v121, v100 offset:23352
    ds_read_b32 v122, v101 offset:23296
    ds_read_b32 v123, v101 offset:23352
    ds_write_b32 v102, v124 offset:9792
    ds_write_b32 v102, v125 offset:10192
    s_waitcnt lgkmcnt(8)
    v_perm_b32 v126, v119, v118, v103
    v_perm_b32 v127, v119, v118, v104
    v_pk_add_f16 v126, v116, v126
    v_pk_add_f16 v127, v117, v127
    ds_read_b32 v112, v100 offset:26208
    ds_read_b32 v113, v100 offset:26264
    ds_read_b32 v114, v101 offset:26208
    ds_read_b32 v115, v101 offset:26264
    ds_write_b32 v102, v126 offset:11424
    ds_write_b32 v102, v127 offset:11824
    s_waitcnt lgkmcnt(8)
    v_perm_b32 v124, v123, v122, v103
    v_perm_b32 v125, v123, v122, v104
    v_pk_add_f16 v124, v120, v124
    v_pk_add_f16 v125, v121, v125
    ds_read_b32 v116, v100 offset:29120
    ds_read_b32 v117, v100 offset:29176
    ds_read_b32 v118, v101 offset:29120
    ds_read_b32 v119, v101 offset:29176
    ds_write_b32 v102, v124 offset:13056
    ds_write_b32 v102, v125 offset:13456
    s_waitcnt lgkmcnt(8)
    v_perm_b32 v126, v115, v114, v103
    v_perm_b32 v127, v115, v114, v104
    v_pk_add_f16 v126, v112, v126
    v_pk_add_f16 v127, v113, v127
    ds_read_b32 v120, v100 offset:32032
    ds_read_b32 v121, v100 offset:32088
    ds_read_b32 v122, v101 offset:32032
    ds_read_b32 v123, v101 offset:32088
    ds_write_b32 v102, v126 offset:14688
    ds_write_b32 v102, v127 offset:15088
    s_waitcnt lgkmcnt(8)
    v_perm_b32 v124, v119, v118, v103
    v_perm_b32 v125, v119, v118, v104
    v_pk_add_f16 v124, v116, v124
    v_pk_add_f16 v125, v117, v125
    ds_read_b32 v112, v100 offset:34944
    ds_read_b32 v113, v100 offset:35000
    ds_read_b32 v114, v101 offset:34944
    ds_read_b32 v115, v101 offset:35000
    ds_write_b32 v102, v124 offset:16320
    ds_write_b32 v102, v125 offset:16720
    s_waitcnt lgkmcnt(8)
    v_perm_b32 v126, v123, v122, v103
    v_perm_b32 v127, v123, v122, v104
    v_pk_add_f16 v126, v120, v126
    v_pk_add_f16 v127, v121, v127
    ds_write_b32 v102, v126 offset:17952
    ds_write_b32 v102, v127 offset:18352
    s_waitcnt lgkmcnt(4)
    v_perm_b32 v124, v115, v114, v103
    v_perm_b32 v125, v115, v114, v104
    v_pk_add_f16 v124, v112, v124
    v_pk_add_f16 v125, v113, v125
    ds_write_b32 v102, v124 offset:19584
    ds_write_b32 v102, v125 offset:19984
    s_waitcnt lgkmcnt(0)
    s_mov_b64 exec, 1
    ds_add_u32 v165, v166 offset:12
    s_mov_b64 exec, -1
    s_endpgm
L_end:
    s_endpgm
.p2align 6
L_items2:
    .long 0x1000000
    .long 0x10100
    .long 0x20200
    .long 0x30300
    .long 0x40400
    .long 0x50500
    .long 0x60600
    .long 0x70700
    .long 0x80800
    .long 0x90900
    .long 0xa0a00
    .long 0xb0b00
    .long 0xc0c00
    .long 0x10d0101
    .long 0xe0201
    .long 0xf0301
    .long 0x100401
    .long 0x110501
    .long 0x120601
    .long 0x130701
    .long 0x140801
    .long 0x150901
    .long 0x160a01
    .long 0x170b01
    .long 0x180c01
    .long 0x1190202
    .long 0x1a0302
    .long 0x1b0402
    .long 0x1c0502
    .long 0x1d0602
    .long 0x1e0702
    .long 0x1f0802
    .long 0x200902
    .long 0x210a02
    .long 0x220b02
    .long 0x230c02
    .long 0x1240303
    .long 0x250403
    .long 0x260503
    .long 0x270603
    .long 0x280703
    .long 0x290803
    .long 0x2a0903
    .long 0x2b0a03
    .long 0x2c0b03
    .long 0x2d0c03
    .long 0x12e0404
    .long 0x2f0504
    .long 0x300604
    .long 0x310704
    .long 0x320804
    .long 0x330904
    .long 0x340a04
    .long 0x350b04
    .long 0x360c04
    .long 0x1370505
    .long 0x380605
    .long 0x390705
    .long 0x3a0805
    .long 0x3b0905
    .long 0x3c0a05
    .long 0x3d0b05
    .long 0x3e0c05
    .long 0x13f0606
    .long 0x400706
    .long 0x410806
    .long 0x420906
    .long 0x430a06
    .long 0x440b06
    .long 0x450c06
    .long 0x1460707
    .long 0x470807
    .long 0x480907
    .long 0x490a07
    .long 0x4a0b07
    .long 0x4b0c07
    .long 0x14c0808
    .long 0x4d0908
    .long 0x4e0a08
    .long 0x4f0b08
    .long 0x500c08
    .long 0x1510909
    .long 0x520a09
    .long 0x530b09
    .long 0x540c09
    .long 0x1550a0a
    .long 0x560b0a
    .long 0x570c0a
    .long 0x1580b0b
    .long 0x590c0b
    .long 0x15a0c0c
    .long 0x15b0000
    .long 0x15b0000
    .long 0x15b0000
    .long 0x15b0000
    .long 0x15b0000
    .long 0x15b0000
    .long 0x15b0000
    .long 0x15b0000
    .long 0x15b0000
    .long 0x15b0000
    .long 0x15b0000
    .long 0x15b0000
    .long 0x15b0000
    .long 0x15b0000
    .long 0x15b0000
    .long 0x15b0000
    .long 0x15b0000
    .long 0x15b0000
    .long 0x15b0000
    .long 0x15b0000
    .long 0x15b0000
    .long 0x15b0000
    .long 0x15b0000
    .long 0x15b0000
    .long 0x15b0000
    .long 0x15b0000
    .long 0x15b0000
    .long 0x15b0000
    .long 0x15b0000
    .long 0x15b0000
    .long 0x15b0000
    .long 0x15b0000
    .long 0x15b0000
    .long 0x15b0000
    .long 0x15b0000
    .long 0x15b0000
    .long 0x15b0000
    .long 0x11000000
    .long 0x10010100
    .long 0x10020200
    .long 0x10030300
    .long 0x10040400
    .long 0x10050500
    .long 0x10060600
    .long 0x10070700
    .long 0x10080800
    .long 0x10090900
    .long 0x100a0a00
    .long 0x100b0b00
    .long 0x100c0c00
    .long 0x110d0101
    .long 0x100e0201
    .long 0x100f0301
    .long 0x10100401
    .long 0x10110501
    .long 0x10120601
    .long 0x10130701
    .long 0x10140801
    .long 0x10150901
    .long 0x10160a01
    .long 0x10170b01
    .long 0x10180c01
    .long 0x11190202
    .long 0x101a0302
    .long 0x101b0402
    .long 0x101c0502
    .long 0x101d0602
    .long 0x101e0702
    .long 0x101f0802
    .long 0x10200902
    .long 0x10210a02
    .long 0x10220b02
    .long 0x10230c02
    .long 0x11240303
    .long 0x10250403
    .long 0x10260503
    .long 0x10270603
    .long 0x10280703
    .long 0x10290803
    .long 0x102a0903
    .long 0x102b0a03
    .long 0x102c0b03
    .long 0x102d0c03
    .long 0x112e0404
    .long 0x102f0504
    .long 0x10300604
    .long 0x10310704
    .long 0x10320804
    .long 0x10330904
    .long 0x10340a04
    .long 0x10350b04
    .long 0x10360c04
    .long 0x11370505
    .long 0x10380605
    .long 0x10390705
    .long 0x103a0805
    .long 0x103b0905
    .long 0x103c0a05
    .long 0x103d0b05
    .long 0x103e0c05
    .long 0x113f0606
    .long 0x10400706
    .long 0x10410806
    .long 0x10420906
    .long 0x10430a06
    .long 0x10440b06
    .long 0x10450c06
    .long 0x11460707
    .long 0x10470807
    .long 0x10480907
    .long 0x10490a07
    .long 0x104a0b07
    .long 0x104b0c07
    .long 0x114c0808
    .long 0x104d0908
    .long 0x104e0a08
    .long 0x104f0b08
    .long 0x10500c08
    .long 0x11510909
    .long 0x10520a09
    .long 0x10530b09
    .long 0x10540c09
    .long 0x11550a0a
    .long 0x10560b0a
    .long 0x10570c0a
    .long 0x11580b0b
    .long 0x10590c0b
    .long 0x115a0c0c
    .long 0x115b0000
    .long 0x115b0000
    .long 0x115b0000
    .long 0x115b0000
    .long 0x115b0000
    .long 0x115b0000
    .long 0x115b0000
    .long 0x115b0000
    .long 0x115b0000
    .long 0x115b0000
    .long 0x115b0000
    .long 0x115b0000
    .long 0x115b0000
    .long 0x115b0000
    .long 0x115b0000
    .long 0x115b0000
    .long 0x115b0000
    .long 0x115b0000
    .long 0x115b0000
    .long 0x115b0000
    .long 0x115b0000
    .long 0x115b0000
    .long 0x115b0000
    .long 0x115b0000
    .long 0x115b0000
    .long 0x115b0000
    .long 0x115b0000
    .long 0x115b0000
    .long 0x115b0000
    .long 0x115b0000
    .long 0x115b0000
    .long 0x115b0000
    .long 0x115b0000
    .long 0x115b0000
    .long 0x115b0000
    .long 0x115b0000
    .long 0x115b0000
L_pwtab:
    .long 0x3400
    .long 0x3801
    .long 0x3c04
    .long 0x4005
    .long 0x4408
    .long 0x4809
    .long 0x14c0c
    .long 0x8402
    .long 0x8803
    .long 0x8c06
    .long 0x9007
    .long 0x940a
    .long 0x980b
    .long 0x29c0c
    .long 0x340d
    .long 0x380e
    .long 0x3c11
    .long 0x4012
    .long 0x4415
    .long 0x4816
    .long 0x14c19
    .long 0x840f
    .long 0x8810
    .long 0x8c13
    .long 0x9014
    .long 0x9417
    .long 0x9818
    .long 0x29c19
    .long 0x341a
    .long 0x381b
    .long 0x3c1e
    .long 0x401f
    .long 0x4422
    .long 0x4823
    .long 0x14c26
    .long 0x841c
    .long 0x881d
    .long 0x8c20
    .long 0x9021
    .long 0x9424
    .long 0x9825
    .long 0x29c26
    .long 0x0
    .long 0x0
    .long 0x0
    .long 0x0
    .long 0x0
    .long 0x0
    .long 0x0
    .long 0x0
    .long 0x0
    .long 0x0
    .long 0x0
    .long 0x0
    .long 0x0
    .long 0x0
    .long 0x0
    .long 0x0
    .long 0x0
    .long 0x0
    .long 0x0
    .long 0x0
    .long 0x0
    .long 0x0
L_code_end:
.section .rodata,"a"
.p2align 6
.amdhsa_kernel standalone__deep_cross_xdeepfm__recsys_kernel
  .amdhsa_next_free_vgpr 168
  .amdhsa_next_free_sgpr 102
  .amdhsa_accum_offset 168
  .amdhsa_group_segment_fixed_size 0
  .amdhsa_kernarg_size 88
  .amdhsa_user_sgpr_count 2
  .amdhsa_user_sgpr_kernarg_segment_ptr 1
  .amdhsa_system_sgpr_workgroup_id_x 1
.end_amdhsa_kernel
```
